```python
import torch

def _softmax(x, axis=-1):
    return torch.softmax(x, dim=axis)
def _gelu(x):
    return torch.nn.functional.gelu(x, approximate="tanh")
def _silu(x):
    return torch.nn.functional.silu(x)
def _sigmoid(x):
    return torch.sigmoid(x)
def _layernorm(x, axis=-1, eps=1e-5):
    m = x.mean(dim=axis, keepdim=True)
    v = x.var(dim=axis, keepdim=True, unbiased=False)
    return (x - m) / torch.sqrt(v + eps)
def _scatter_add(tgt, idx, src, axis=0):
    return tgt.clone().index_add_(axis, idx, src)
def _segment_sum(src, seg, n):
    out = torch.zeros((n,) + src.shape[1:], dtype=src.dtype)
    return out.index_add_(0, seg, src)
def _pad(x, pw):
    flat = tuple(v for pair in reversed(pw) for v in pair)
    return torch.nn.functional.pad(x, flat)

kernel_name = 'concat_heads__sliding_block__sliding_block__prompt'

def setup_inputs():

    _w = (lambda a: (lambda t: t.to(torch.bfloat16) if t.is_floating_point() else t)(torch.as_tensor(a)))
    def _A_setup():
        B, S, D = 1, 2048, 640
        return {
            "x": _w((lambda *s: torch.randn(*s, dtype=torch.bfloat16) * 0.2)(B, S, D)),
            "wqkv": _w((lambda *s: torch.randn(*s, dtype=torch.bfloat16) * 0.2)(D, 3 * D)),
            "wo": _w((lambda *s: torch.randn(*s, dtype=torch.bfloat16) * 0.05)(D, D)),
        }
    _A_in = _A_setup()

    def _B_setup():
        B, S, D = 1, 2048, 640
        return {
            "x": _w((lambda *s: torch.randn(*s, dtype=torch.bfloat16) * 0.2)(B, S, D)),
            "wqkv": _w((lambda *s: torch.randn(*s, dtype=torch.bfloat16) * 0.2)(D, 3 * D)),
            "wo": _w((lambda *s: torch.randn(*s, dtype=torch.bfloat16) * 0.05)(D, D)),
        }
    _B_in = _B_setup()

    return {
        "A_x": _A_in["x"],
        "A_wqkv": _A_in["wqkv"],
        "A_wo": _A_in["wo"],
        "B_x": _B_in["x"],
        "B_wqkv": _B_in["wqkv"],
        "B_wo": _B_in["wo"],
    }

def reference(A_x, A_wqkv, A_wo, B_x, B_wqkv, B_wo):
    def _A_ref(x, wqkv, wo):
        B, S, D = x.shape
        H = 32; Dh = D // H; W = 256
        qkv = (lambda x, *d: x.permute(*d))((x @ wqkv).reshape(B, S, 3, H, Dh), 2, 0, 3, 1, 4)
        q, k, v = qkv[0], qkv[1], qkv[2]
        scores = torch.einsum("bhqd,bhkd->bhqk", q, k) * (Dh ** -0.5)
        idx = torch.arange(S)
        mask = (idx[:, None] - idx[None, :] >= 0) & (idx[:, None] - idx[None, :] < W)
        scores = torch.where(mask[None, None], scores, -1e9)
        p = _softmax(scores, axis=-1)
        o = torch.einsum("bhqk,bhkd->bhqd", p, v)
        return (lambda x, *d: x.permute(*d))(o, 0, 2, 1, 3).reshape(B, S, D) @ wo

    def _B_ref(x, wqkv, wo):
        B, S, D = x.shape
        H = 32; Dh = D // H; W = 256
        qkv = (lambda x, *d: x.permute(*d))((x @ wqkv).reshape(B, S, 3, H, Dh), 2, 0, 3, 1, 4)
        q, k, v = qkv[0], qkv[1], qkv[2]
        scores = torch.einsum("bhqd,bhkd->bhqk", q, k) * (Dh ** -0.5)
        idx = torch.arange(S)
        mask = (idx[:, None] - idx[None, :] >= 0) & (idx[:, None] - idx[None, :] < W)
        scores = torch.where(mask[None, None], scores, -1e9)
        p = _softmax(scores, axis=-1)
        o = torch.einsum("bhqk,bhkd->bhqd", p, v)
        return (lambda x, *d: x.permute(*d))(o, 0, 2, 1, 3).reshape(B, S, D) @ wo

    a = _A_ref(A_x, A_wqkv, A_wo)
    b = _B_ref(B_x, B_wqkv, B_wo)
    return torch.concatenate([a, b], axis=-1)
```

```asm
; @launch grid=(256,1,1) block=(512,1,1) lds=163840
.amdgcn_target "amdgcn-amd-amdhsa--gfx950"
.text
.globl concat_heads__sliding_block__sliding_block__prompt_kernel
.p2align 8
.type concat_heads__sliding_block__sliding_block__prompt_kernel,@function
concat_heads__sliding_block__sliding_block__prompt_kernel:
    s_load_dwordx16 s[4:19], s[0:1], 0
    s_cmp_ge_u32 s2, 256
    s_cbranch_scc1 L_end
    s_getpc_b64 s[44:45]
L_t2:
    s_lshr_b32 s51, s2, 3
    v_lshrrev_b32 v1, 6, v0
    s_mov_b32 s47, 0x20000
    v_readfirstlane_b32 s48, v1
    s_mov_b32 s46, L_codeend-L_t2
    s_lshl_b32 s3, s48, 5
    s_add_u32 s3, s3, s51
    s_lshl_b32 s3, s3, 7
    s_mov_b64 exec, 1
    buffer_load_dword v29, off, s[44:47], s3
    s_mov_b64 exec, -1
    s_load_dwordx2 s[40:41], s[0:1], 64
    s_cmp_ge_u32 s48, 4
    s_cbranch_scc1 L_t3
    v_and_b32 v2, 127, v0
    s_and_b32 s3, s2, 2
    s_lshl_b32 s3, s3, 4
    s_add_u32 s3, s3, s51
    s_lshl_b32 s3, s3, 6
    s_mul_i32 s20, s51, 24
    s_and_b32 s21, s2, 1
    s_add_u32 s20, s20, s21
    s_cmp_lt_u32 s48, 2
    s_cselect_b32 s3, s3, s20
    s_cselect_b32 s20, 31, 11
    s_cselect_b32 s21, 1, 4
    s_cselect_b32 s22, 2, 3
    s_mulk_i32 s3, 640
    v_bfe_u32 v3, v2, 0, s22
    v_lshrrev_b32 v2, s22, v2
    v_min_u32 v2, s20, v2
    v_min_u32 v3, s21, v3
    v_mul_u32_u24 v2, 10, v2
    v_add_lshl_u32 v2, v2, v3, 7
    s_mov_b32 s46, 2457600
    s_cselect_b32 s46, 2621440, s46
    s_waitcnt lgkmcnt(0)
    s_cselect_b64 s[44:45], s[4:5], s[6:7]
    s_cselect_b64 s[20:21], s[10:11], s[12:13]
    s_bitcmp0_b32 s2, 2
    s_cselect_b64 s[44:45], s[44:45], s[20:21]
    buffer_load_dword v29, v2, s[44:47], s3 offen
L_t3:
    v_and_b32 v0, 63, v0
    s_bfe_u32 s100, s2, 0x10002
    s_and_b32 s49, s2, 2
    s_lshl_b32 s49, s49, 1
    s_and_b32 s3, s51, 3
    s_add_u32 s49, s49, s3
    s_and_b32 s101, s2, 1
    s_lshl_b32 s101, s101, 3
    s_lshr_b32 s52, s51, 2
    s_add_u32 s101, s101, s52
    s_mov_b32 s26, 2621440
    s_mov_b32 s27, s47
    s_mov_b32 s30, 2457600
    s_mov_b32 s31, s47
    s_mov_b32 s34, 819200
    s_mov_b32 s35, s47
    s_mov_b32 s38, 5242880
    s_mov_b32 s39, s47
    s_movk_i32 s46, 256
    s_mov_b32 s42, 50331648
    s_mov_b32 s43, s47
    s_cmp_lt_u32 s48, 4
    s_cbranch_scc1 L_compute
    s_setprio 1
    s_and_b32 s67, s48, 3
    v_lshrrev_b32 v1, 3, v0
    v_lshrrev_b32 v5, 4, v0
    v_and_b32 v6, 7, v0
    v_xor_b32 v6, v6, v5
    v_lshlrev_b32 v6, 4, v6
    v_mul_u32_u24 v1, 1280, v1
    s_lshl_b32 s3, s49, 2
    s_add_u32 s3, s3, s67
    s_mul_i32 s3, s3, 81920
    v_add3_u32 v200, v1, v6, s3
    v_xor_b32 v201, 64, v200
    v_add_u32 v202, 40960, v200
    v_xor_b32 v203, 64, v202
    v_mul_u32_u24 v2, 3840, v5
    s_mul_i32 s3, s67, 61440
    s_mul_i32 s20, s101, 80
    s_add_u32 s3, s3, s20
    v_and_b32 v6, 15, v0
    v_lshlrev_b32 v7, 2, v5
    v_xor_b32 v6, v6, v7
    v_mul_u32_u24 v7, 13108, v6
    v_lshrrev_b32 v7, 16, v7
    v_mul_u32_u24 v7, 1200, v7
    v_lshl_add_u32 v7, v6, 4, v7
    v_add_u32 v3, 1, v6
    v_lshrrev_b32 v3, 4, v3
    v_lshl_add_u32 v7, v3, 30, v7
    v_add3_u32 v204, v7, v2, s3
    v_xor_b32 v6, 2, v6
    s_add_u32 s3, s3, 30720
    v_mul_u32_u24 v7, 13108, v6
    v_lshrrev_b32 v7, 16, v7
    v_mul_u32_u24 v7, 1200, v7
    v_lshl_add_u32 v7, v6, 4, v7
    v_add_u32 v3, 1, v6
    v_lshrrev_b32 v3, 4, v3
    v_lshl_add_u32 v7, v3, 30, v7
    v_add3_u32 v205, v7, v2, s3
    s_lshr_b32 s3, s52, 1
    s_sub_u32 s3, s51, s3
    s_and_b32 s65, s3, 1
    s_lshr_b32 s22, s52, 2
    s_xor_b32 s22, s52, s22
    s_cmp_eq_u32 s65, 0
    s_cbranch_scc1 L_os0
    s_mov_b32 s20, 2017677345
    s_mov_b32 s21, 1733444353
    s_bitcmp1_b32 s3, 1
    s_cselect_b32 s20, 2488672305, s20
    s_cselect_b32 s21, 1685398273, s21
    s_cselect_b32 s3, 8, 0
    s_bitcmp1_b32 s22, 0
    s_cselect_b32 s0, s21, s20
    s_cselect_b32 s20, 16, 0
    s_add_u32 s3, s3, s20
    s_lshr_b32 s1, 2307491734, s3
    s_branch L_os1
L_os0:
    s_mov_b32 s20, 1749242144
    s_mov_b32 s21, 1985167888
    s_bitcmp1_b32 s3, 1
    s_cselect_b32 s20, 2504401200, s20
    s_cselect_b32 s21, 1702113808, s21
    s_cselect_b32 s3, 8, 0
    s_bitcmp1_b32 s22, 0
    s_cselect_b32 s0, s21, s20
    s_cselect_b32 s20, 16, 0
    s_add_u32 s3, s3, s20
    s_lshr_b32 s1, 2560133015, s3
L_os1:
    s_lshl_b32 s3, s3, 1
    s_lshr_b64 s[20:21], 9568330, s3
    s_mov_b32 s66, s20
    v_and_b32 v6, 3, v0
    v_min_u32 v6, 2, v6
    v_mul_u32_u24 v6, 1280, v6
    v_lshrrev_b32 v7, 2, v0
    s_and_b32 s3, s51, 3
    s_lshl_b32 s3, s3, 1
    s_add_u32 s3, s3, s65
    s_lshl_b32 s3, s3, 2
    s_add_u32 s3, s3, s67
    s_mul_i32 s3, s3, 12
    s_and_b32 s20, s2, 1
    s_add_u32 s3, s3, s20
    s_mulk_i32 s3, 640
    s_addk_i32 s3, 256
    v_mul_u32_u24 v7, 3840, v7
    v_add3_u32 v206, v6, v7, s3
    s_cmp_eq_u32 s65, 0
    s_cbranch_scc1 L_nosw
    v_swap_b32 v204, v205
    v_swap_b32 v200, v202
    v_swap_b32 v201, v203
L_nosw:
    s_lshl_b32 s3, s67, 1
    s_add_u32 s65, s65, s3
    s_lshl_b32 s65, s65, 11
    s_mov_b32 s63, 0
    s_mov_b32 s64, 0
    s_sub_u32 s53, 11, s48
    s_cmp_eq_u32 s100, 0
    s_waitcnt lgkmcnt(0)
    s_cselect_b64 s[24:25], s[4:5], s[10:11]
    s_cselect_b64 s[28:29], s[6:7], s[12:13]
    s_cselect_b64 s[32:33], s[8:9], s[14:15]
    s_mov_b64 s[36:37], s[16:17]
    s_mov_b64 s[44:45], s[18:19]
    s_call_b64 s[22:23], L_ldfront
    s_call_b64 s[22:23], L_su0
    s_call_b64 s[22:23], L_su1
    s_call_b64 s[22:23], L_su2
    s_call_b64 s[22:23], L_su3
    s_branch L_ld_go
L_ldfront:
    s_and_b32 s4, s0, 15
    s_lshr_b64 s[0:1], s[0:1], 4
    s_lshl_b32 s8, s4, 7
    s_mul_i32 s9, s4, 245760
    s_bitcmp1_b32 s66, s64
    s_cselect_b32 s4, s9, 1073741824
    s_mov_b64 exec, 0xff
    buffer_load_dword v29, v206, s[28:31], s4 offen
    s_mov_b64 exec, -1
L_wtx:
    s_add_u32 s11, s65, s63
    s_add_u32 s10, s11, s65
    s_add_u32 m0, s11, 32768
    s_add_u32 s4, s9, 0
    buffer_load_dwordx4 v204, s[28:31], s4 offen lds
    s_add_u32 m0, s10, 0
    s_add_u32 s4, s8, 0
    buffer_load_dwordx4 v200, s[24:27], s4 offen lds
    s_add_u32 m0, s10, 1024
    s_add_u32 s4, s8, 10240
    buffer_load_dwordx4 v200, s[24:27], s4 offen lds
    s_add_u32 m0, s11, 33792
    s_add_u32 s4, s9, 15360
    buffer_load_dwordx4 v204, s[28:31], s4 offen lds
    s_add_u32 m0, s10, 2048
    s_add_u32 s4, s8, 20480
    buffer_load_dwordx4 v201, s[24:27], s4 offen lds
    s_add_u32 m0, s10, 3072
    s_add_u32 s4, s8, 30720
    buffer_load_dwordx4 v201, s[24:27], s4 offen lds
    s_cmp_lg_u32 s64, 0
    s_cbranch_scc1 L_ld_go
    s_setpc_b64 s[22:23]
L_ld_go:
    s_xor_b32 s10, s10, 4096
    s_xor_b32 s11, s11, 2048
    s_add_u32 m0, s11, 32768
    s_add_u32 s4, s9, 0
    buffer_load_dwordx4 v205, s[28:31], s4 offen lds
    s_add_u32 m0, s10, 0
    s_add_u32 s4, s8, 0
    buffer_load_dwordx4 v202, s[24:27], s4 offen lds
    s_add_u32 m0, s10, 1024
    s_add_u32 s4, s8, 10240
    buffer_load_dwordx4 v202, s[24:27], s4 offen lds
    s_cmp_eq_u32 s64, 0
    s_cbranch_scc1 L_ld_wb
    s_waitcnt vmcnt(10)
    s_barrier
L_ld_wb:
    s_add_u32 m0, s11, 33792
    s_add_u32 s4, s9, 15360
    buffer_load_dwordx4 v205, s[28:31], s4 offen lds
    s_add_u32 m0, s10, 2048
    s_add_u32 s4, s8, 20480
    buffer_load_dwordx4 v203, s[24:27], s4 offen lds
    s_add_u32 m0, s10, 3072
    s_add_u32 s4, s8, 30720
    buffer_load_dwordx4 v203, s[24:27], s4 offen lds
    s_sub_u32 s63, s63, 49152
    s_cselect_b32 s63, 98304, s63
    s_add_u32 s64, s64, 1
    s_cmp_lt_u32 s64, 10
    s_cbranch_scc1 L_ldfront
    s_getpc_b64 s[24:25]
L_cp2:
    s_lshl_b32 s4, s51, 2
    s_add_u32 s4, s4, s67
    s_lshl_b32 s5, s4, 7
    s_mov_b32 s26, L_codeend-L_cp2
    s_mov_b64 exec, 1
    buffer_load_dword v29, off, s[24:27], s5
    s_mov_b64 exec, -1
    s_lshl_b32 s4, s51, 2
    s_add_u32 s4, s4, s67
    s_mulk_i32 s4, 6400
    v_min_u32 v1, 49, v0
    v_lshlrev_b32 v1, 7, v1
    buffer_load_dword v29, v1, s[32:35], s4 offen
    s_add_u32 s8, s48, 8
    s_mov_b32 s9, 16
    s_mov_b32 s10, 4
    s_call_b64 s[22:23], L_wodma
    s_load_dwordx16 s[12:27], s[44:45], 0
    s_waitcnt vmcnt(7)
    s_barrier
    s_waitcnt lgkmcnt(0)
    s_and_b64 s[12:13], s[12:13], s[20:21]
    s_and_b64 s[14:15], s[14:15], s[22:23]
    s_and_b64 s[16:17], s[16:17], s[24:25]
    s_and_b64 s[18:19], s[18:19], s[26:27]
    s_and_b64 s[12:13], s[12:13], s[16:17]
    s_and_b64 s[14:15], s[14:15], s[18:19]
    s_and_b64 s[12:13], s[12:13], s[14:15]
    s_and_b32 s12, s12, s13
    s_cbranch_scc1 L_rstok
    v_and_b32 v2, 15, v0
    v_lshlrev_b32 v2, 2, v2
    s_mov_b32 s4, 0
L_rst:
    buffer_load_dword v1, v2, s[44:47], 0 offen sc1
    s_add_u32 s4, s4, 1
    s_waitcnt vmcnt(0)
    v_cmp_eq_u32 vcc, 0, v1
    s_cmp_gt_u32 s4, 65536
    s_cbranch_scc1 L_rstok
    s_cbranch_vccnz L_rst
L_rstok:
    s_call_b64 s[22:23], L_wodma
    s_barrier
    s_branch L_attn
L_su0:
    v_lshlrev_b32 v16, 4, v0
    v_and_b32 v1, 31, v0
    v_lshrrev_b32 v5, 5, v0
    v_lshlrev_b32 v6, 2, v5
    v_sub_u32 v6, v1, v6
    v_mov_b32 v7, 0xff800000
    v_subrev_u32 v1, 0, v6
    v_and_b32 v32, v7, v1
    v_subrev_u32 v1, 1, v6
    v_and_b32 v33, v7, v1
    v_subrev_u32 v1, 2, v6
    v_and_b32 v34, v7, v1
    v_subrev_u32 v1, 3, v6
    v_and_b32 v35, v7, v1
    v_subrev_u32 v1, 8, v6
    v_and_b32 v36, v7, v1
    v_subrev_u32 v1, 9, v6
    v_and_b32 v37, v7, v1
    v_subrev_u32 v1, 10, v6
    v_and_b32 v38, v7, v1
    v_subrev_u32 v1, 11, v6
    v_and_b32 v39, v7, v1
    v_subrev_u32 v1, 16, v6
    v_and_b32 v40, v7, v1
    v_subrev_u32 v1, 17, v6
    v_and_b32 v41, v7, v1
    v_subrev_u32 v1, 18, v6
    v_and_b32 v42, v7, v1
    v_subrev_u32 v1, 19, v6
    v_and_b32 v43, v7, v1
    v_subrev_u32 v1, 24, v6
    v_and_b32 v44, v7, v1
    v_subrev_u32 v1, 25, v6
    v_and_b32 v45, v7, v1
    v_subrev_u32 v1, 26, v6
    v_and_b32 v46, v7, v1
    v_subrev_u32 v1, 27, v6
    v_and_b32 v47, v7, v1
    v_and_b32 v6, 7, v0
    v_bfe_u32 v7, v0, 4, 2
    v_lshl_add_u32 v6, v7, 3, v6
    v_lshlrev_b32 v6, 4, v6
    v_and_b32 v7, 8, v0
    v_add_u32 v6, v6, v7
    v_add_u32 v18, 2048, v6
    v_and_b32 v6, 19, v0
    v_bfe_u32 v7, v0, 2, 1
    v_lshl_add_u32 v6, v7, 3, v6
    v_bfe_u32 v7, v0, 3, 1
    v_lshl_add_u32 v6, v7, 2, v6
    v_min_u32 v6, 21, v6
    v_and_b32 v7, 27, v0
    v_cmp_eq_u32 s[12:13], 24, v7
    v_mul_u32_u24 v5, 384, v5
    v_add_u32 v5, 2560, v5
    v_cndmask_b32 v6, v6, 20, s[12:13]
    v_lshl_add_u32 v17, v6, 4, v5
    s_setpc_b64 s[22:23]
L_su1:
    s_mul_i32 s3, s53, 5632
    v_add_u32 v19, s3, v16
    v_add_u32 v21, s3, v18
    v_add_u32 v20, s3, v17
    s_mul_i32 s3, s53, 2560
    s_add_u32 s3, s3, 90112
    v_add_u32 v26, s3, v16
    v_add_u32 v27, s3, v18
    v_mov_b32 v22, 163584
    v_mov_b32 v23, 1
    s_lshl_b32 s3, s48, 2
    v_add_u32 v24, s3, v22
    v_lshlrev_b32 v25, 6, v0
    s_lshl_b32 s4, s100, 3
    s_add_u32 s4, s4, s49
    s_lshl_b32 s50, s4, 4
    s_add_u32 s50, s50, s101
    s_lshl_b32 s62, s50, 7
    s_add_u32 s62, s62, s3
    s_add_u32 s62, s62, 17825792
    s_mul_i32 s61, s50, 45056
    s_add_u32 s61, s61, 86016
    s_lshl_b32 s54, 16, s53
    s_cmp_eq_u32 s53, 1
    s_cselect_b32 s54, 0, s54
    s_cselect_b32 s55, 0, 1
    s_cmp_eq_u32 s49, 0
    s_cselect_b32 s55, 0, s55
    s_bitset1_b32 s54, s53
    s_lshl_b32 s4, s4, 3
    s_add_u32 s4, s4, s53
    s_lshl_b32 s56, s4, 4
    s_add_u32 s56, s56, s101
    s_mulk_i32 s56, 2560
    s_add_u32 s56, s56, 12582912
    s_lshl_b32 s57, s4, 7
    s_add_u32 s57, s57, s101
    s_lshl_b32 s57, s57, 2
    s_add_u32 s57, s57, 17858560
    s_setpc_b64 s[22:23]
L_su2:
    s_and_b32 s4, s2, 3
    s_lshl_b32 s4, s4, 1
    s_and_b32 s3, s51, 1
    s_add_u32 s4, s4, s3
    s_lshl_b32 s4, s4, 3
    s_and_b32 s3, s48, 4
    s_add_u32 s4, s4, s3
    s_and_b32 s3, s51, 2
    s_add_u32 s4, s4, s3
    s_bfe_u32 s3, s48, 0x10001
    s_add_u32 s4, s4, s3
    s_and_b32 s5, s48, 1
    s_lshl_b32 s60, s4, 1
    s_add_u32 s60, s60, s5
    s_lshl_b32 s60, s60, 5
    s_add_u32 s60, s60, s100
    s_lshl_b32 s60, s60, 3
    s_add_u32 s60, s60, s52
    s_mulk_i32 s60, 160
    s_lshl_b32 s3, s100, 6
    s_add_u32 s4, s4, s3
    s_lshl_b32 s58, s4, 3
    s_add_u32 s58, s58, s52
    s_lshl_b32 s58, s58, 6
    s_add_u32 s58, s58, 17858560
    s_mulk_i32 s4, 160
    s_add_u32 s4, s4, s5
    s_lshl_b32 s4, s4, 8
    s_add_u32 s4, s4, 12582912
    s_mul_i32 s59, s52, 5
    s_lshr_b32 s59, s59, 2
    s_lshl_b32 s59, s59, 12
    v_and_b32 v1, 15, v0
    v_lshrrev_b32 v2, 4, v0
    v_lshl_add_u32 v8, v1, 4, s4
    v_lshl_add_u32 v8, v2, 9, v8
    s_and_b32 s3, s48, 3
    s_mulk_i32 s3, 2560
    s_cmp_lt_u32 s48, 4
    s_cselect_b32 s4, 0, 50688
    s_add_u32 s3, s3, s4
    v_lshl_add_u32 v3, v1, 2, v2
    v_mad_u32_u24 v11, v3, 40, s3
    v_add_u32 v12, s3, v16
    v_bfe_u32 v3, v0, 2, 2
    v_lshl_add_u32 v3, v2, 3, v3
    v_and_b32 v4, 1, v2
    v_lshl_add_u32 v3, v4, 2, v3
    v_and_b32 v4, 3, v0
    v_lshl_add_u32 v3, v3, 2, v4
    v_xor_b32 v4, 16, v3
    s_mov_b32 s3, 61184
    v_mad_u32_u24 v9, v3, 40, s3
    v_mad_u32_u24 v10, v4, 40, s3
    v_add_u32 v1, 0, v0
    v_mul_u32_u24 v2, 6554, v1
    v_lshrrev_b32 v2, 16, v2
    v_mul_u32_u24 v2, 2400, v2
    v_lshl_add_u32 v13, v1, 4, v2
    v_add_u32 v1, 64, v0
    v_mul_u32_u24 v2, 6554, v1
    v_lshrrev_b32 v2, 16, v2
    v_mul_u32_u24 v2, 2400, v2
    v_lshl_add_u32 v14, v1, 4, v2
    v_add_u32 v1, 128, v0
    v_mul_u32_u24 v2, 6554, v1
    v_lshrrev_b32 v2, 16, v2
    v_mul_u32_u24 v2, 2400, v2
    v_lshl_add_u32 v15, v1, 4, v2
    s_setpc_b64 s[22:23]
L_su3:
    s_mul_i32 s3, s52, 160
    v_add_u32 v1, 0, v0
    v_mul_u32_u24 v5, 6554, v1
    v_lshrrev_b32 v5, 16, v5
    v_mul_u32_u24 v6, 10, v5
    v_sub_u32 v6, v1, v6
    v_lshrrev_b32 v7, 1, v5
    v_and_b32 v7, 4, v7
    v_xor_b32 v5, v5, v7
    v_mul_u32_u24 v5, 1280, v5
    v_lshl_add_u32 v5, v6, 4, v5
    v_add_u32 v192, s3, v5
    s_sub_u32 s3, s3, 1024
    v_add_u32 v1, 64, v0
    v_mul_u32_u24 v5, 6554, v1
    v_lshrrev_b32 v5, 16, v5
    v_mul_u32_u24 v6, 10, v5
    v_sub_u32 v6, v1, v6
    v_lshrrev_b32 v7, 1, v5
    v_and_b32 v7, 4, v7
    v_xor_b32 v5, v5, v7
    v_mul_u32_u24 v5, 1280, v5
    v_lshl_add_u32 v5, v6, 4, v5
    v_add_u32 v193, s3, v5
    s_sub_u32 s3, s3, 1024
    v_add_u32 v1, 128, v0
    v_mul_u32_u24 v5, 6554, v1
    v_lshrrev_b32 v5, 16, v5
    v_mul_u32_u24 v6, 10, v5
    v_sub_u32 v6, v1, v6
    v_lshrrev_b32 v7, 1, v5
    v_and_b32 v7, 4, v7
    v_xor_b32 v5, v5, v7
    v_mul_u32_u24 v5, 1280, v5
    v_lshl_add_u32 v5, v6, 4, v5
    v_add_u32 v194, s3, v5
    s_sub_u32 s3, s3, 1024
    v_add_u32 v1, 192, v0
    v_mul_u32_u24 v5, 6554, v1
    v_lshrrev_b32 v5, 16, v5
    v_mul_u32_u24 v6, 10, v5
    v_sub_u32 v6, v1, v6
    v_lshrrev_b32 v7, 1, v5
    v_and_b32 v7, 4, v7
    v_xor_b32 v5, v5, v7
    v_mul_u32_u24 v5, 1280, v5
    v_lshl_add_u32 v5, v6, 4, v5
    v_add_u32 v195, s3, v5
    s_add_u32 s3, s3, 3072
    v_add_u32 v1, 256, v0
    v_mul_u32_u24 v5, 6554, v1
    v_lshrrev_b32 v5, 16, v5
    v_mul_u32_u24 v6, 10, v5
    v_sub_u32 v6, v1, v6
    v_lshrrev_b32 v7, 1, v5
    v_and_b32 v7, 4, v7
    v_xor_b32 v5, v5, v7
    v_mul_u32_u24 v5, 1280, v5
    v_lshl_add_u32 v5, v6, 4, v5
    v_add_u32 v196, s3, v5
L_su4:
    v_mov_b32 v2, 0xff800000
    v_mov_b32 v90, 0
    v_mov_b32 v91, 0
    v_mov_b32 v94, 0
    v_mov_b32 v95, 0
    v_mov_b32 v106, 0
    v_mov_b32 v107, 0
    v_xor_b32 v48, v2, v32
    v_xor_b32 v49, v2, v33
    v_xor_b32 v50, v2, v34
    v_xor_b32 v51, v2, v35
    v_xor_b32 v52, v2, v36
    v_xor_b32 v53, v2, v37
    v_xor_b32 v54, v2, v38
    v_xor_b32 v55, v2, v39
    v_xor_b32 v56, v2, v40
    v_xor_b32 v57, v2, v41
    v_xor_b32 v58, v2, v42
    v_xor_b32 v59, v2, v43
    v_xor_b32 v60, v2, v44
    v_xor_b32 v61, v2, v45
    v_xor_b32 v62, v2, v46
    v_xor_b32 v63, v2, v47
    s_setpc_b64 s[22:23]
L_compute:
    s_mov_b32 s53, s48
    s_cmp_eq_u32 s100, 0
    s_waitcnt lgkmcnt(0)
    s_cselect_b64 s[24:25], s[4:5], s[10:11]
    s_cselect_b64 s[28:29], s[6:7], s[12:13]
    s_cselect_b64 s[32:33], s[8:9], s[14:15]
    s_mov_b64 s[36:37], s[16:17]
    s_mov_b64 s[44:45], s[18:19]
    s_call_b64 s[22:23], L_su0
    v_mov_b32 v8, 0
    v_mov_b32 v13, 0
    v_mov_b32 v14, 0
    v_mov_b32 v15, 0
    v_mov_b32 v25, 0
    v_mov_b32 v4, 0
    v_mov_b32 v5, 0
    v_mov_b32 v6, 0
    v_mov_b32 v7, 0
    v_and_b32 v1, 48, v16
    v_add_u32 v1, 163584, v1
    ds_write_b128 v1, v[4:7]
    s_lshr_b32 s66, s51, 4
    s_mul_i32 s11, s66, 12
    s_add_u32 s11, s11, 4
    s_xor_b32 s11, s11, s51
    s_lshl_b32 s66, s66, 3
    s_and_b32 s3, s2, 7
    s_add_u32 s66, s66, s3
    s_mul_i32 s4, s66, 6144
    s_lshl_b32 s66, s66, 2
    s_or_b32 s11, s11, s48
    s_cselect_b32 s65, 99, 2
    s_cbranch_scc1 L_noreset
    s_add_u32 s4, s4, 17825792
    s_add_u32 s5, s4, 3072
    buffer_store_dwordx4 v[4:7], v16, s[40:43], s4 offen offset:0 sc1
    buffer_store_dwordx4 v[4:7], v16, s[40:43], s4 offen offset:1024 sc1
    buffer_store_dwordx4 v[4:7], v16, s[40:43], s4 offen offset:2048 sc1
    buffer_store_dwordx4 v[4:7], v16, s[40:43], s5 offen offset:0 sc1
    buffer_store_dwordx4 v[4:7], v16, s[40:43], s5 offen offset:1024 sc1
    buffer_store_dwordx4 v[4:7], v16, s[40:43], s5 offen offset:2048 sc1
L_noreset:
    v_mov_b32 v48, 0
    v_mov_b32 v49, 0
    v_mov_b32 v50, 0
    v_mov_b32 v51, 0
    s_mul_i32 s4, s48, 5632
    s_add_u32 s4, s4, 45056
    v_mfma_f32_32x32x16_bf16 v[128:143], v[48:51], v[48:51], 0
    s_mul_i32 s7, s48, 2560
    s_add_u32 s7, s7, 90112
    v_and_b32 v1, 15, v0
    v_lshrrev_b32 v2, 4, v0
    v_and_b32 v3, 8, v0
    v_mfma_f32_32x32x16_bf16 v[144:159], v[48:51], v[48:51], 0
    v_add_u32 v3, v3, v1
    v_lshlrev_b32 v4, 4, v3
    v_lshl_add_u32 v4, v2, 9, v4
    v_add_u32 v122, s4, v4
    v_add_u32 v125, s7, v4
    v_mfma_f32_32x32x16_bf16 v[160:175], v[48:51], v[48:51], 0
    v_mul_u32_u24 v4, 384, v2
    v_add_u32 v4, 2560, v4
    v_add_u32 v4, s4, v4
    v_lshl_add_u32 v123, v1, 4, v4
    v_bfe_u32 v5, v0, 2, 1
    v_mfma_f32_32x32x16_bf16 v[176:191], v[48:51], v[48:51], 0
    v_mul_u32_u24 v5, 1536, v5
    v_and_b32 v6, 3, v0
    v_lshlrev_b32 v7, 4, v6
    v_add3_u32 v5, v5, v7, v4
    v_and_b32 v7, 8, v0
    v_mfma_f32_32x32x16_bf16 v[192:207], v[48:51], v[48:51], 0
    v_lshl_add_u32 v5, v7, 3, v5
    v_add_u32 v124, 256, v5
    v_cmp_gt_u32 vcc, 32, v0
    v_mov_b32 v5, 0x3ea52b5c
    v_mov_b32 v4, s4
    v_mfma_f32_32x32x16_bf16 v[208:223], v[48:51], v[48:51], 0
    v_cndmask_b32 v30, 1.0, v5, vcc
    v_mov_b32 v5, s7
    v_cndmask_b32 v4, v4, v5, vcc
    v_and_b32 v5, 0x1f0, v16
    v_add_u32 v5, 2048, v5
    v_mfma_f32_32x32x16_bf16 v[224:239], v[48:51], v[48:51], 0
    v_add_u32 v127, v4, v5
    v_mov_b32 v4, 22528
    v_mov_b32 v5, 10240
    v_cndmask_b32 v4, v4, v5, vcc
    v_add_u32 v126, v4, v127
    v_mfma_f32_32x32x16_bf16 v[240:255], v[48:51], v[48:51], 0
    v_and_b32 v7, 11, v0
    v_cmp_eq_u32 vcc, 8, v7
    v_lshrrev_b32 v1, 1, v1
    v_xor_b32 v1, v1, v2
    v_cndmask_b32 v7, 0, 1.0, vcc
    v_mfma_f32_32x32x16_bf16 v[64:79], v[48:51], v[48:51], 0
    v_lshlrev_b32 v1, 4, v1
    v_lshl_add_u32 v1, v3, 7, v1
    s_lshl_b32 s4, s48, 12
    v_add_u32 v112, s4, v1
    v_xor_b32 v113, 64, v112
    v_mfma_f32_32x32x16_bf16 v[80:95], v[48:51], v[48:51], 0
    v_bfe_u32 v3, v0, 2, 2
    v_lshl_add_u32 v4, v2, 3, v3
    v_lshlrev_b32 v4, 8, v4
    v_lshl_add_u32 v4, v3, 6, v4
    v_and_b32 v5, 1, v2
    v_mfma_f32_32x32x16_bf16 v[96:111], v[48:51], v[48:51], 0
    v_lshl_add_u32 v4, v5, 5, v4
    v_and_b32 v5, 1, v0
    v_lshl_add_u32 v4, v5, 3, v4
    v_add_u32 v4, 32768, v4
    v_bfe_u32 v5, v0, 1, 1
    v_mad_u32_u24 v6, v5, 3, 0
    v_lshlrev_b32 v6, 4, v6
    v_xor_b32 v114, v6, v4
    v_mad_u32_u24 v6, v5, 3, 1
    v_lshlrev_b32 v6, 4, v6
    v_xor_b32 v115, v6, v4
    v_mad_u32_u24 v6, v5, 3, 5
    v_lshlrev_b32 v6, 4, v6
    v_xor_b32 v116, v6, v4
    v_mad_u32_u24 v6, v5, 3, 6
    v_lshlrev_b32 v6, 4, v6
    v_xor_b32 v117, v6, v4
    v_mad_u32_u24 v6, v5, 1, 10
    v_lshlrev_b32 v6, 4, v6
    v_xor_b32 v118, v6, v4
    v_mad_u32_u24 v6, v5, 1, 13
    v_lshlrev_b32 v6, 4, v6
    v_xor_b32 v119, v6, v4
    v_mad_u32_u24 v6, v5, 5, 2
    v_lshlrev_b32 v6, 4, v6
    v_xor_b32 v120, v6, v4
    v_mad_u32_u24 v6, v5, 3, 12
    v_lshlrev_b32 v6, 4, v6
    v_xor_b32 v121, v6, v4
    v_mov_b32 v156, v7
    v_mov_b32 v157, v7
    v_mov_b32 v158, v7
    v_mov_b32 v159, v7
    v_mov_b32 v188, v7
    v_mov_b32 v189, v7
    v_mov_b32 v190, v7
    v_mov_b32 v191, v7
    v_mov_b32 v220, v7
    v_mov_b32 v221, v7
    v_mov_b32 v222, v7
    v_mov_b32 v223, v7
    v_mov_b32 v252, v7
    v_mov_b32 v253, v7
    v_mov_b32 v254, v7
    v_mov_b32 v255, v7
    s_mov_b32 s7, 4294918144
    s_mov_b32 s63, 0
    s_mov_b32 s64, 0
    s_mov_b32 s10, 0x3ea52b5c
    s_mov_b32 s11, s10
    s_waitcnt lgkmcnt(0)
L_gemm:
    s_barrier
    v_mfma_f32_16x16x32_bf16 v[228:231], v[84:87], v[76:79], v[228:231]
    ds_read_b64_tr_b16 v[88:89], v116 offset:0
    ds_read_b64_tr_b16 v[90:91], v116 offset:1024
    v_mfma_f32_16x16x32_bf16 v[196:199], v[84:87], v[72:75], v[196:199]
    ds_read_b128 v[48:51], v112 offset:0
    ds_read_b128 v[52:55], v112 offset:1024
    v_mfma_f32_16x16x32_bf16 v[164:167], v[84:87], v[68:71], v[164:167]
    ds_read_b128 v[56:59], v112 offset:16384
    ds_read_b128 v[60:63], v112 offset:17408
    v_mfma_f32_16x16x32_bf16 v[132:135], v[84:87], v[64:67], v[132:135]
    ds_read_b64_tr_b16 v[92:93], v117 offset:0
    ds_read_b64_tr_b16 v[94:95], v117 offset:1024
    s_waitcnt lgkmcnt(5)
    v_mfma_f32_16x16x32_bf16 v[136:139], v[88:91], v[48:51], v[136:139]
    ds_read_b64_tr_b16 v[96:97], v118 offset:0
    s_waitcnt lgkmcnt(5)
    v_mfma_f32_16x16x32_bf16 v[168:171], v[88:91], v[52:55], v[168:171]
    ds_read_b64_tr_b16 v[98:99], v118 offset:1024
    s_waitcnt lgkmcnt(5)
    v_mfma_f32_16x16x32_bf16 v[200:203], v[88:91], v[56:59], v[200:203]
    ds_read_b64_tr_b16 v[100:101], v119 offset:0
    s_waitcnt lgkmcnt(5)
    v_mfma_f32_16x16x32_bf16 v[232:235], v[88:91], v[60:63], v[232:235]
    ds_read_b64_tr_b16 v[102:103], v119 offset:1024
    s_waitcnt lgkmcnt(4)
    v_mfma_f32_16x16x32_bf16 v[236:239], v[92:95], v[60:63], v[236:239]
    ds_read_b64_tr_b16 v[108:109], v121 offset:0
    v_mfma_f32_16x16x32_bf16 v[204:207], v[92:95], v[56:59], v[204:207]
    ds_read_b64_tr_b16 v[110:111], v121 offset:1024
    v_mfma_f32_16x16x32_bf16 v[172:175], v[92:95], v[52:55], v[172:175]
    ds_read_b64_tr_b16 v[104:105], v120 offset:0
    v_mfma_f32_16x16x32_bf16 v[140:143], v[92:95], v[48:51], v[140:143]
    ds_read_b64_tr_b16 v[106:107], v120 offset:1024
    s_waitcnt lgkmcnt(6)
    v_mfma_f32_16x16x32_bf16 v[144:147], v[48:51], v[96:99], v[144:147]
    ds_read_b64_tr_b16 v[80:81], v114 offset:0
    v_mfma_f32_16x16x32_bf16 v[176:179], v[52:55], v[96:99], v[176:179]
    ds_read_b64_tr_b16 v[82:83], v114 offset:1024
    v_mfma_f32_16x16x32_bf16 v[208:211], v[56:59], v[96:99], v[208:211]
    ds_read_b64_tr_b16 v[84:85], v115 offset:0
    v_mfma_f32_16x16x32_bf16 v[240:243], v[60:63], v[96:99], v[240:243]
    ds_read_b64_tr_b16 v[86:87], v115 offset:1024
    s_waitcnt lgkmcnt(6)
    v_mfma_f32_16x16x32_bf16 v[244:247], v[60:63], v[100:103], v[244:247]
    ds_read_b128 v[64:67], v113 offset:0
    v_mfma_f32_16x16x32_bf16 v[212:215], v[56:59], v[100:103], v[212:215]
    ds_read_b128 v[68:71], v113 offset:1024
    v_mfma_f32_16x16x32_bf16 v[180:183], v[52:55], v[100:103], v[180:183]
    ds_read_b128 v[72:75], v113 offset:16384
    v_mfma_f32_16x16x32_bf16 v[148:151], v[48:51], v[100:103], v[148:151]
    ds_read_b128 v[76:79], v113 offset:17408
    v_mfma_f32_16x16x32_bf16 v[156:159], v[48:51], v[108:111], v[156:159]
    ds_read_b64_tr_b16 v[88:89], v116 offset:8192
    v_mfma_f32_16x16x32_bf16 v[188:191], v[52:55], v[108:111], v[188:191]
    ds_read_b64_tr_b16 v[90:91], v116 offset:9216
    v_mfma_f32_16x16x32_bf16 v[220:223], v[56:59], v[108:111], v[220:223]
    ds_read_b64_tr_b16 v[92:93], v117 offset:8192
    v_mfma_f32_16x16x32_bf16 v[252:255], v[60:63], v[108:111], v[252:255]
    ds_read_b64_tr_b16 v[94:95], v117 offset:9216
    s_waitcnt lgkmcnt(6)
    v_mfma_f32_16x16x32_bf16 v[248:251], v[104:107], v[60:63], v[248:251]
    ds_read_b64_tr_b16 v[96:97], v118 offset:8192
    v_mfma_f32_16x16x32_bf16 v[216:219], v[104:107], v[56:59], v[216:219]
    ds_read_b64_tr_b16 v[98:99], v118 offset:9216
    v_mfma_f32_16x16x32_bf16 v[184:187], v[104:107], v[52:55], v[184:187]
    ds_read_b64_tr_b16 v[100:101], v119 offset:8192
    v_mfma_f32_16x16x32_bf16 v[152:155], v[104:107], v[48:51], v[152:155]
    ds_read_b64_tr_b16 v[102:103], v119 offset:9216
    v_mfma_f32_16x16x32_bf16 v[128:131], v[80:83], v[48:51], v[128:131]
    ds_read_b64_tr_b16 v[108:109], v121 offset:8192
    v_mfma_f32_16x16x32_bf16 v[160:163], v[80:83], v[52:55], v[160:163]
    ds_read_b64_tr_b16 v[110:111], v121 offset:9216
    v_mfma_f32_16x16x32_bf16 v[192:195], v[80:83], v[56:59], v[192:195]
    ds_read_b64_tr_b16 v[104:105], v120 offset:8192
    v_mfma_f32_16x16x32_bf16 v[224:227], v[80:83], v[60:63], v[224:227]
    ds_read_b64_tr_b16 v[106:107], v120 offset:9216
    v_mfma_f32_16x16x32_bf16 v[228:231], v[84:87], v[60:63], v[228:231]
    ds_read_b64_tr_b16 v[80:81], v114 offset:8192
    v_mfma_f32_16x16x32_bf16 v[196:199], v[84:87], v[56:59], v[196:199]
    ds_read_b64_tr_b16 v[82:83], v114 offset:9216
    v_mfma_f32_16x16x32_bf16 v[164:167], v[84:87], v[52:55], v[164:167]
    s_cmp_eq_u32 s63, 9
    v_mfma_f32_16x16x32_bf16 v[132:135], v[84:87], v[48:51], v[132:135]
    s_cbranch_scc1 L_glast
    s_waitcnt lgkmcnt(4)
    v_mfma_f32_16x16x32_bf16 v[136:139], v[88:91], v[64:67], v[136:139]
    ds_read_b64_tr_b16 v[84:85], v115 offset:8192
    v_mfma_f32_16x16x32_bf16 v[168:171], v[88:91], v[68:71], v[168:171]
    ds_read_b64_tr_b16 v[86:87], v115 offset:9216
    v_mfma_f32_16x16x32_bf16 v[200:203], v[88:91], v[72:75], v[200:203]
    v_mfma_f32_16x16x32_bf16 v[232:235], v[88:91], v[76:79], v[232:235]
    v_mfma_f32_16x16x32_bf16 v[236:239], v[92:95], v[76:79], v[236:239]
    v_mfma_f32_16x16x32_bf16 v[204:207], v[92:95], v[72:75], v[204:207]
    v_mfma_f32_16x16x32_bf16 v[172:175], v[92:95], v[68:71], v[172:175]
    s_cmp_eq_u32 s63, 1
    v_mfma_f32_16x16x32_bf16 v[140:143], v[92:95], v[64:67], v[140:143]
    s_cbranch_scc1 L_chk
L_chkx:
    v_mfma_f32_16x16x32_bf16 v[144:147], v[64:67], v[96:99], v[144:147]
    v_mfma_f32_16x16x32_bf16 v[176:179], v[68:71], v[96:99], v[176:179]
    s_sub_u32 s64, s64, 1
    v_mfma_f32_16x16x32_bf16 v[208:211], v[72:75], v[96:99], v[208:211]
    s_cselect_b32 s4, 98304, s7
    v_mfma_f32_16x16x32_bf16 v[240:243], v[76:79], v[96:99], v[240:243]
    s_cselect_b32 s64, 2, s64
    v_mfma_f32_16x16x32_bf16 v[244:247], v[76:79], v[100:103], v[244:247]
    s_cmp_eq_u32 s63, s65
    v_mfma_f32_16x16x32_bf16 v[212:215], v[72:75], v[100:103], v[212:215]
    s_cbranch_scc1 L_atom
L_atomx:
    v_mfma_f32_16x16x32_bf16 v[180:183], v[68:71], v[100:103], v[180:183]
    v_add_u32 v112, s4, v112
    v_mfma_f32_16x16x32_bf16 v[148:151], v[64:67], v[100:103], v[148:151]
    v_add_u32 v113, s4, v113
    v_mfma_f32_16x16x32_bf16 v[156:159], v[64:67], v[108:111], v[156:159]
    v_add_u32 v114, s4, v114
    v_mfma_f32_16x16x32_bf16 v[188:191], v[68:71], v[108:111], v[188:191]
    v_add_u32 v115, s4, v115
    v_mfma_f32_16x16x32_bf16 v[220:223], v[72:75], v[108:111], v[220:223]
    v_add_u32 v116, s4, v116
    v_mfma_f32_16x16x32_bf16 v[252:255], v[76:79], v[108:111], v[252:255]
    v_add_u32 v117, s4, v117
    s_waitcnt lgkmcnt(0)
    v_mfma_f32_16x16x32_bf16 v[248:251], v[104:107], v[76:79], v[248:251]
    v_add_u32 v118, s4, v118
    v_mfma_f32_16x16x32_bf16 v[216:219], v[104:107], v[72:75], v[216:219]
    v_add_u32 v119, s4, v119
    v_mfma_f32_16x16x32_bf16 v[184:187], v[104:107], v[68:71], v[184:187]
    v_add_u32 v120, s4, v120
    v_mfma_f32_16x16x32_bf16 v[152:155], v[104:107], v[64:67], v[152:155]
    v_add_u32 v121, s4, v121
    v_mfma_f32_16x16x32_bf16 v[128:131], v[80:83], v[64:67], v[128:131]
    v_mfma_f32_16x16x32_bf16 v[160:163], v[80:83], v[68:71], v[160:163]
    s_add_u32 s63, s63, 1
    v_mfma_f32_16x16x32_bf16 v[192:195], v[80:83], v[72:75], v[192:195]
    v_mfma_f32_16x16x32_bf16 v[224:227], v[80:83], v[76:79], v[224:227]
    s_waitcnt lgkmcnt(0)
    s_branch L_gemm
L_glast:
    s_setprio 2
    s_add_u32 s6, s61, 22528
    s_waitcnt lgkmcnt(6)
    v_mfma_f32_16x16x32_bf16 v[200:203], v[88:91], v[72:75], v[200:203]
    ds_read_b64_tr_b16 v[84:85], v115 offset:8192
    ds_read_b64_tr_b16 v[86:87], v115 offset:9216
    v_mfma_f32_16x16x32_bf16 v[232:235], v[88:91], v[76:79], v[232:235]
    v_mfma_f32_16x16x32_bf16 v[204:207], v[92:95], v[72:75], v[204:207]
    v_mfma_f32_16x16x32_bf16 v[236:239], v[92:95], v[76:79], v[236:239]
    v_mfma_f32_16x16x32_bf16 v[208:211], v[72:75], v[96:99], v[208:211]
    v_mfma_f32_16x16x32_bf16 v[240:243], v[76:79], v[96:99], v[240:243]
    v_mfma_f32_16x16x32_bf16 v[212:215], v[72:75], v[100:103], v[212:215]
    v_mfma_f32_16x16x32_bf16 v[244:247], v[76:79], v[100:103], v[244:247]
    s_waitcnt lgkmcnt(6)
    v_mfma_f32_16x16x32_bf16 v[220:223], v[72:75], v[108:111], v[220:223]
    s_waitcnt lgkmcnt(0)
    v_mfma_f32_16x16x32_bf16 v[252:255], v[76:79], v[108:111], v[252:255]
    v_mfma_f32_16x16x32_bf16 v[216:219], v[104:107], v[72:75], v[216:219]
    v_cvt_pk_bf16_f32 v200, v200, v201
    v_cvt_pk_bf16_f32 v201, v202, v203
    v_cvt_pk_bf16_f32 v202, v204, v205
    v_mfma_f32_16x16x32_bf16 v[248:251], v[104:107], v[76:79], v[248:251]
    v_cvt_pk_bf16_f32 v203, v206, v207
    ds_write_b128 v122, v[200:203] offset:22528
    v_cvt_pk_bf16_f32 v232, v232, v233
    v_mfma_f32_16x16x32_bf16 v[192:195], v[80:83], v[72:75], v[192:195]
    v_cvt_pk_bf16_f32 v233, v234, v235
    v_cvt_pk_bf16_f32 v234, v236, v237
    v_cvt_pk_bf16_f32 v235, v238, v239
    v_mfma_f32_16x16x32_bf16 v[224:227], v[80:83], v[76:79], v[224:227]
    ds_write_b128 v122, v[232:235] offset:22656
    v_cvt_pk_bf16_f32 v208, v208, v209
    v_cvt_pk_bf16_f32 v209, v210, v211
    v_mfma_f32_16x16x32_bf16 v[196:199], v[84:87], v[72:75], v[196:199]
    v_cvt_pk_bf16_f32 v210, v240, v241
    v_cvt_pk_bf16_f32 v211, v242, v243
    ds_write_b128 v123, v[208:211] offset:22528
    v_mfma_f32_16x16x32_bf16 v[228:231], v[84:87], v[76:79], v[228:231]
    v_cvt_pk_bf16_f32 v212, v212, v213
    v_cvt_pk_bf16_f32 v213, v214, v215
    v_cvt_pk_bf16_f32 v214, v244, v245
    v_mfma_f32_16x16x32_bf16 v[136:139], v[88:91], v[64:67], v[136:139]
    v_cvt_pk_bf16_f32 v215, v246, v247
    ds_write_b128 v123, v[212:215] offset:24064
    v_cvt_pk_bf16_f32 v220, v220, v221
    v_mfma_f32_16x16x32_bf16 v[168:171], v[88:91], v[68:71], v[168:171]
    v_cvt_pk_bf16_f32 v221, v222, v223
    v_cvt_pk_bf16_f32 v222, v252, v253
    v_cvt_pk_bf16_f32 v223, v254, v255
    v_mfma_f32_16x16x32_bf16 v[140:143], v[92:95], v[64:67], v[140:143]
    ds_write_b128 v124, v[220:223] offset:22528
    v_pk_mul_f32 v[216:217], v[216:217], v[30:31] op_sel_hi:[1,0]
    v_pk_mul_f32 v[218:219], v[218:219], v[30:31] op_sel_hi:[1,0]
    v_mfma_f32_16x16x32_bf16 v[172:175], v[92:95], v[68:71], v[172:175]
    v_pk_mul_f32 v[248:249], v[248:249], v[30:31] op_sel_hi:[1,0]
    v_pk_mul_f32 v[250:251], v[250:251], v[30:31] op_sel_hi:[1,0]
    v_cvt_pk_bf16_f32 v216, v216, v217
    v_mfma_f32_16x16x32_bf16 v[144:147], v[64:67], v[96:99], v[144:147]
    v_cvt_pk_bf16_f32 v217, v218, v219
    v_cvt_pk_bf16_f32 v218, v248, v249
    v_cvt_pk_bf16_f32 v219, v250, v251
    v_mfma_f32_16x16x32_bf16 v[176:179], v[68:71], v[96:99], v[176:179]
    ds_write_b128 v126, v[216:219]
    v_pk_mul_f32 v[192:193], v[192:193], s[10:11]
    v_pk_mul_f32 v[194:195], v[194:195], s[10:11]
    v_mfma_f32_16x16x32_bf16 v[148:151], v[64:67], v[100:103], v[148:151]
    v_pk_mul_f32 v[196:197], v[196:197], s[10:11]
    v_pk_mul_f32 v[198:199], v[198:199], s[10:11]
    v_cvt_pk_bf16_f32 v192, v192, v193
    v_mfma_f32_16x16x32_bf16 v[180:183], v[68:71], v[100:103], v[180:183]
    v_cvt_pk_bf16_f32 v193, v194, v195
    v_cvt_pk_bf16_f32 v194, v196, v197
    v_cvt_pk_bf16_f32 v195, v198, v199
    v_mfma_f32_16x16x32_bf16 v[156:159], v[64:67], v[108:111], v[156:159]
    ds_write_b128 v125, v[192:195] offset:10240
    v_pk_mul_f32 v[224:225], v[224:225], s[10:11]
    v_pk_mul_f32 v[226:227], v[226:227], s[10:11]
    v_mfma_f32_16x16x32_bf16 v[188:191], v[68:71], v[108:111], v[188:191]
    v_pk_mul_f32 v[228:229], v[228:229], s[10:11]
    v_pk_mul_f32 v[230:231], v[230:231], s[10:11]
    v_cvt_pk_bf16_f32 v224, v224, v225
    v_mfma_f32_16x16x32_bf16 v[152:155], v[104:107], v[64:67], v[152:155]
    v_cvt_pk_bf16_f32 v225, v226, v227
    v_cvt_pk_bf16_f32 v226, v228, v229
    v_cvt_pk_bf16_f32 v227, v230, v231
    v_mfma_f32_16x16x32_bf16 v[184:187], v[104:107], v[68:71], v[184:187]
    ds_write_b128 v125, v[224:227] offset:10368
    v_mfma_f32_16x16x32_bf16 v[128:131], v[80:83], v[64:67], v[128:131]
    v_mfma_f32_16x16x32_bf16 v[160:163], v[80:83], v[68:71], v[160:163]
    v_mfma_f32_16x16x32_bf16 v[132:135], v[84:87], v[64:67], v[132:135]
    v_mfma_f32_16x16x32_bf16 v[164:167], v[84:87], v[68:71], v[164:167]
    s_waitcnt lgkmcnt(0)
    s_barrier
    buffer_store_dwordx4 v[200:203], v122, s[40:43], s6 offen offset:0 sc1
    buffer_store_dwordx4 v[232:235], v122, s[40:43], s6 offen offset:128 sc1
    buffer_store_dwordx4 v[208:211], v123, s[40:43], s6 offen offset:0 sc1
    buffer_store_dwordx4 v[212:215], v123, s[40:43], s6 offen offset:1536 sc1
    buffer_store_dwordx4 v[220:223], v124, s[40:43], s6 offen offset:0 sc1
    s_mov_b32 exec_lo, 0
    buffer_store_dwordx4 v[216:219], v127, s[40:43], s6 offen offset:0 sc1
    s_mov_b32 exec_lo, -1
    v_cvt_pk_bf16_f32 v136, v136, v137
    v_cvt_pk_bf16_f32 v137, v138, v139
    v_cvt_pk_bf16_f32 v138, v140, v141
    v_cvt_pk_bf16_f32 v139, v142, v143
    ds_write_b128 v122, v[136:139] offset:0
    v_cvt_pk_bf16_f32 v168, v168, v169
    v_cvt_pk_bf16_f32 v169, v170, v171
    v_cvt_pk_bf16_f32 v170, v172, v173
    v_cvt_pk_bf16_f32 v171, v174, v175
    ds_write_b128 v122, v[168:171] offset:128
    v_cvt_pk_bf16_f32 v144, v144, v145
    v_cvt_pk_bf16_f32 v145, v146, v147
    v_cvt_pk_bf16_f32 v146, v176, v177
    v_cvt_pk_bf16_f32 v147, v178, v179
    ds_write_b128 v123, v[144:147] offset:0
    v_cvt_pk_bf16_f32 v148, v148, v149
    v_cvt_pk_bf16_f32 v149, v150, v151
    v_cvt_pk_bf16_f32 v150, v180, v181
    v_cvt_pk_bf16_f32 v151, v182, v183
    ds_write_b128 v123, v[148:151] offset:1536
    v_cvt_pk_bf16_f32 v156, v156, v157
    v_cvt_pk_bf16_f32 v157, v158, v159
    v_cvt_pk_bf16_f32 v158, v188, v189
    v_cvt_pk_bf16_f32 v159, v190, v191
    ds_write_b128 v124, v[156:159] offset:0
    v_pk_mul_f32 v[152:153], v[152:153], v[30:31] op_sel_hi:[1,0]
    v_pk_mul_f32 v[154:155], v[154:155], v[30:31] op_sel_hi:[1,0]
    v_pk_mul_f32 v[184:185], v[184:185], v[30:31] op_sel_hi:[1,0]
    v_pk_mul_f32 v[186:187], v[186:187], v[30:31] op_sel_hi:[1,0]
    v_cvt_pk_bf16_f32 v152, v152, v153
    v_cvt_pk_bf16_f32 v153, v154, v155
    v_cvt_pk_bf16_f32 v154, v184, v185
    v_cvt_pk_bf16_f32 v155, v186, v187
    ds_write_b128 v127, v[152:155]
    v_pk_mul_f32 v[128:129], v[128:129], s[10:11]
    v_pk_mul_f32 v[130:131], v[130:131], s[10:11]
    v_pk_mul_f32 v[132:133], v[132:133], s[10:11]
    v_pk_mul_f32 v[134:135], v[134:135], s[10:11]
    v_cvt_pk_bf16_f32 v128, v128, v129
    v_cvt_pk_bf16_f32 v129, v130, v131
    v_cvt_pk_bf16_f32 v130, v132, v133
    v_cvt_pk_bf16_f32 v131, v134, v135
    ds_write_b128 v125, v[128:131] offset:0
    v_pk_mul_f32 v[160:161], v[160:161], s[10:11]
    v_pk_mul_f32 v[162:163], v[162:163], s[10:11]
    v_pk_mul_f32 v[164:165], v[164:165], s[10:11]
    v_pk_mul_f32 v[166:167], v[166:167], s[10:11]
    v_cvt_pk_bf16_f32 v160, v160, v161
    v_cvt_pk_bf16_f32 v161, v162, v163
    v_cvt_pk_bf16_f32 v162, v164, v165
    v_cvt_pk_bf16_f32 v163, v166, v167
    ds_write_b128 v125, v[160:163] offset:128
    s_waitcnt lgkmcnt(0)
    s_barrier
    s_cmp_eq_u32 s49, 0
    s_cselect_b32 s11, 1, s48
    s_mov_b64 exec, 1
    s_waitcnt vmcnt(0)
    buffer_store_dword v23, off, s[40:43], s62 sc1
    s_mov_b64 exec, -1
    buffer_store_dwordx4 v[136:139], v122, s[40:43], s61 offen offset:0 sc1
    buffer_store_dwordx4 v[168:171], v122, s[40:43], s61 offen offset:128 sc1
    buffer_store_dwordx4 v[144:147], v123, s[40:43], s61 offen offset:0 sc1
    buffer_store_dwordx4 v[148:151], v123, s[40:43], s61 offen offset:1536 sc1
    buffer_store_dwordx4 v[156:159], v124, s[40:43], s61 offen offset:0 sc1
    s_mov_b32 exec_lo, 0
    buffer_store_dwordx4 v[152:155], v127, s[40:43], s61 offen offset:0 sc1
    s_mov_b32 exec_lo, -1
    s_call_b64 s[22:23], L_su4
    s_cmp_lg_u32 s11, 0
    s_cbranch_scc1 L_lof
    s_mov_b32 s6, s62
    s_call_b64 s[22:23], L_kvget
    s_mov_b64 exec, 1
    s_waitcnt vmcnt(22)
    buffer_store_dword v23, off, s[40:43], s6 offset:64 sc1
    s_waitcnt vmcnt(1)
    ds_or_b32 v22, v23 offset:8
    s_mov_b64 exec, -1
    s_setprio 0
    s_branch L_attn
L_lof:
    s_mov_b64 exec, 1
    s_waitcnt vmcnt(0)
    buffer_store_dword v23, off, s[40:43], s62 offset:64 sc1
    s_mov_b64 exec, -1
    s_cmp_eq_u32 s48, 1
    s_cbranch_scc1 L_attn
    s_setprio 0
L_attn:
    ds_read_b128 v[80:83], v26
    ds_read_b128 v[96:99], v19 offset:45056
    ds_read_b64 v[88:89], v27
    ds_read_b64 v[104:105], v21 offset:45056
    ds_read_b128 v[84:87], v26 offset:1024
    ds_read_b128 v[100:103], v19 offset:46080
    s_mov_b32 s4, 0
    s_mov_b32 s5, -1
    s_waitcnt lgkmcnt(2)
    v_mfma_f32_32x32x16_bf16 v[160:175], v[96:99], v[80:83], v[32:47]
    v_cndmask_b32 v92, 0, v88, s[4:5]
    v_cndmask_b32 v93, 0, v89, s[4:5]
    v_cndmask_b32 v88, v88, 0, s[4:5]
    v_cndmask_b32 v89, v89, 0, s[4:5]
    s_cmp_lt_u32 s48, 4
    s_waitcnt lgkmcnt(0)
    v_mfma_f32_32x32x16_bf16 v[160:175], v[104:107], v[88:91], v[160:175]
    ds_read_b128 v[112:115], v20 offset:45056
    v_mfma_f32_32x32x16_bf16 v[176:191], v[100:103], v[84:87], v[32:47]
    ds_read_b128 v[116:119], v20 offset:45824
    v_mfma_f32_32x32x16_bf16 v[176:191], v[104:107], v[92:95], v[176:191]
    s_nop 7
    v_exp_f32 v160, v160
    v_exp_f32 v161, v161
    v_exp_f32 v162, v162
    v_exp_f32 v163, v163
    v_cvt_pk_bf16_f32 v64, v160, v161
    v_exp_f32 v164, v164
    v_exp_f32 v165, v165
    v_cvt_pk_bf16_f32 v65, v162, v163
    s_cbranch_scc1 L_nb2
    s_barrier
L_nb2:
    ds_read_b32 v28, v22 offset:8
    ds_read_b128 v[96:99], v19 offset:39424
    ds_read_b64 v[104:105], v21 offset:39424
    s_bitcmp1_b32 s54, 0
    v_exp_f32 v166, v166
    v_exp_f32 v167, v167
    v_cvt_pk_bf16_f32 v66, v164, v165
    v_exp_f32 v168, v168
    v_exp_f32 v169, v169
    v_cvt_pk_bf16_f32 v67, v166, v167
    v_exp_f32 v170, v170
    v_exp_f32 v171, v171
    v_cvt_pk_bf16_f32 v68, v168, v169
    v_exp_f32 v172, v172
    v_exp_f32 v173, v173
    v_cvt_pk_bf16_f32 v69, v170, v171
    v_exp_f32 v174, v174
    v_exp_f32 v175, v175
    v_cvt_pk_bf16_f32 v70, v172, v173
    v_cvt_pk_bf16_f32 v71, v174, v175
    s_waitcnt lgkmcnt(0)
    s_cbranch_scc1 L_st0
L_bk0:
    v_mfma_f32_32x32x16_bf16 v[160:175], v[96:99], v[80:83], 0
    ds_read_b128 v[100:103], v19 offset:40448
    ds_read_b128 v[120:123], v20 offset:46592
    v_exp_f32 v176, v176
    v_exp_f32 v177, v177
    v_exp_f32 v178, v178
    v_exp_f32 v179, v179
    v_cvt_pk_bf16_f32 v72, v176, v177
    v_exp_f32 v180, v180
    v_mfma_f32_32x32x16_bf16 v[160:175], v[104:107], v[88:91], v[160:175]
    ds_read_b128 v[124:127], v20 offset:47360
    v_exp_f32 v181, v181
    v_cvt_pk_bf16_f32 v73, v178, v179
    v_exp_f32 v182, v182
    v_exp_f32 v183, v183
    v_cvt_pk_bf16_f32 v74, v180, v181
    v_exp_f32 v184, v184
    v_mfma_f32_32x32x16_bf16 v[128:143], v[112:115], v[64:67], 0
    v_exp_f32 v185, v185
    v_cvt_pk_bf16_f32 v75, v182, v183
    v_exp_f32 v186, v186
    v_exp_f32 v187, v187
    v_cvt_pk_bf16_f32 v76, v184, v185
    v_exp_f32 v188, v188
    v_mfma_f32_32x32x16_bf16 v[128:143], v[116:119], v[68:71], v[128:143]
    s_waitcnt lgkmcnt(0)
    ds_read_b32 v28, v22 offset:8
    v_exp_f32 v189, v189
    v_cvt_pk_bf16_f32 v77, v186, v187
    v_exp_f32 v190, v190
    v_exp_f32 v191, v191
    v_cvt_pk_bf16_f32 v78, v188, v189
    v_cvt_pk_bf16_f32 v79, v190, v191
    v_mfma_f32_32x32x16_bf16 v[176:191], v[100:103], v[84:87], 0
    ds_read_b128 v[96:99], v19 offset:33792
    ds_read_b128 v[112:115], v20 offset:39424
    v_exp_f32 v160, v160
    v_exp_f32 v161, v161
    v_exp_f32 v162, v162
    v_exp_f32 v163, v163
    v_cvt_pk_bf16_f32 v64, v160, v161
    v_exp_f32 v164, v164
    v_mfma_f32_32x32x16_bf16 v[176:191], v[104:107], v[92:95], v[176:191]
    ds_read_b64 v[104:105], v21 offset:33792
    ds_read_b128 v[116:119], v20 offset:40192
    v_exp_f32 v165, v165
    v_cvt_pk_bf16_f32 v65, v162, v163
    v_exp_f32 v166, v166
    v_exp_f32 v167, v167
    v_cvt_pk_bf16_f32 v66, v164, v165
    v_exp_f32 v168, v168
    v_mfma_f32_32x32x16_bf16 v[144:159], v[120:123], v[72:75], 0
    s_bitcmp1_b32 s54, 1
    v_exp_f32 v169, v169
    v_cvt_pk_bf16_f32 v67, v166, v167
    v_exp_f32 v170, v170
    v_exp_f32 v171, v171
    v_cvt_pk_bf16_f32 v68, v168, v169
    v_exp_f32 v172, v172
    v_mfma_f32_32x32x16_bf16 v[144:159], v[124:127], v[76:79], v[144:159]
    s_waitcnt lgkmcnt(0)
    v_exp_f32 v173, v173
    v_cvt_pk_bf16_f32 v69, v170, v171
    v_exp_f32 v174, v174
    v_exp_f32 v175, v175
    v_cvt_pk_bf16_f32 v70, v172, v173
    v_cvt_pk_bf16_f32 v71, v174, v175
    s_cbranch_scc1 L_st1
L_bk1:
    v_mfma_f32_32x32x16_bf16 v[160:175], v[96:99], v[80:83], 0
    ds_read_b128 v[100:103], v19 offset:34816
    ds_read_b128 v[120:123], v20 offset:40960
    v_exp_f32 v176, v176
    v_exp_f32 v177, v177
    v_exp_f32 v178, v178
    v_exp_f32 v179, v179
    v_cvt_pk_bf16_f32 v72, v176, v177
    v_exp_f32 v180, v180
    v_mfma_f32_32x32x16_bf16 v[160:175], v[104:107], v[88:91], v[160:175]
    ds_read_b128 v[124:127], v20 offset:41728
    v_exp_f32 v181, v181
    v_cvt_pk_bf16_f32 v73, v178, v179
    v_exp_f32 v182, v182
    v_exp_f32 v183, v183
    v_cvt_pk_bf16_f32 v74, v180, v181
    v_exp_f32 v184, v184
    v_mfma_f32_32x32x16_bf16 v[128:143], v[112:115], v[64:67], v[128:143]
    v_exp_f32 v185, v185
    v_cvt_pk_bf16_f32 v75, v182, v183
    v_exp_f32 v186, v186
    v_exp_f32 v187, v187
    v_cvt_pk_bf16_f32 v76, v184, v185
    v_exp_f32 v188, v188
    v_mfma_f32_32x32x16_bf16 v[128:143], v[116:119], v[68:71], v[128:143]
    s_waitcnt lgkmcnt(0)
    ds_read_b32 v28, v22 offset:8
    v_exp_f32 v189, v189
    v_cvt_pk_bf16_f32 v77, v186, v187
    v_exp_f32 v190, v190
    v_exp_f32 v191, v191
    v_cvt_pk_bf16_f32 v78, v188, v189
    v_cvt_pk_bf16_f32 v79, v190, v191
    v_mfma_f32_32x32x16_bf16 v[176:191], v[100:103], v[84:87], 0
    ds_read_b128 v[96:99], v19 offset:28160
    ds_read_b128 v[112:115], v20 offset:33792
    v_exp_f32 v160, v160
    v_exp_f32 v161, v161
    v_exp_f32 v162, v162
    v_exp_f32 v163, v163
    v_cvt_pk_bf16_f32 v64, v160, v161
    v_exp_f32 v164, v164
    v_mfma_f32_32x32x16_bf16 v[176:191], v[104:107], v[92:95], v[176:191]
    ds_read_b64 v[104:105], v21 offset:28160
    ds_read_b128 v[116:119], v20 offset:34560
    v_exp_f32 v165, v165
    v_cvt_pk_bf16_f32 v65, v162, v163
    v_exp_f32 v166, v166
    v_exp_f32 v167, v167
    v_cvt_pk_bf16_f32 v66, v164, v165
    v_exp_f32 v168, v168
    v_mfma_f32_32x32x16_bf16 v[144:159], v[120:123], v[72:75], v[144:159]
    s_bitcmp1_b32 s54, 2
    v_exp_f32 v169, v169
    v_cvt_pk_bf16_f32 v67, v166, v167
    v_exp_f32 v170, v170
    v_exp_f32 v171, v171
    v_cvt_pk_bf16_f32 v68, v168, v169
    v_exp_f32 v172, v172
    v_mfma_f32_32x32x16_bf16 v[144:159], v[124:127], v[76:79], v[144:159]
    s_waitcnt lgkmcnt(0)
    v_exp_f32 v173, v173
    v_cvt_pk_bf16_f32 v69, v170, v171
    v_exp_f32 v174, v174
    v_exp_f32 v175, v175
    v_cvt_pk_bf16_f32 v70, v172, v173
    v_cvt_pk_bf16_f32 v71, v174, v175
    s_cbranch_scc1 L_st2
L_bk2:
    v_mfma_f32_32x32x16_bf16 v[160:175], v[96:99], v[80:83], 0
    ds_read_b128 v[100:103], v19 offset:29184
    ds_read_b128 v[120:123], v20 offset:35328
    v_exp_f32 v176, v176
    v_exp_f32 v177, v177
    v_exp_f32 v178, v178
    v_exp_f32 v179, v179
    v_cvt_pk_bf16_f32 v72, v176, v177
    v_exp_f32 v180, v180
    v_mfma_f32_32x32x16_bf16 v[160:175], v[104:107], v[88:91], v[160:175]
    ds_read_b128 v[124:127], v20 offset:36096
    v_exp_f32 v181, v181
    v_cvt_pk_bf16_f32 v73, v178, v179
    v_exp_f32 v182, v182
    v_exp_f32 v183, v183
    v_cvt_pk_bf16_f32 v74, v180, v181
    v_exp_f32 v184, v184
    v_mfma_f32_32x32x16_bf16 v[128:143], v[112:115], v[64:67], v[128:143]
    v_exp_f32 v185, v185
    v_cvt_pk_bf16_f32 v75, v182, v183
    v_exp_f32 v186, v186
    v_exp_f32 v187, v187
    v_cvt_pk_bf16_f32 v76, v184, v185
    v_exp_f32 v188, v188
    v_mfma_f32_32x32x16_bf16 v[128:143], v[116:119], v[68:71], v[128:143]
    s_waitcnt lgkmcnt(0)
    ds_read_b32 v28, v22 offset:8
    v_exp_f32 v189, v189
    v_cvt_pk_bf16_f32 v77, v186, v187
    v_exp_f32 v190, v190
    v_exp_f32 v191, v191
    v_cvt_pk_bf16_f32 v78, v188, v189
    v_cvt_pk_bf16_f32 v79, v190, v191
    v_mfma_f32_32x32x16_bf16 v[176:191], v[100:103], v[84:87], 0
    ds_read_b128 v[96:99], v19 offset:22528
    ds_read_b128 v[112:115], v20 offset:28160
    v_exp_f32 v160, v160
    v_exp_f32 v161, v161
    v_exp_f32 v162, v162
    v_exp_f32 v163, v163
    v_cvt_pk_bf16_f32 v64, v160, v161
    v_exp_f32 v164, v164
    v_mfma_f32_32x32x16_bf16 v[176:191], v[104:107], v[92:95], v[176:191]
    ds_read_b64 v[104:105], v21 offset:22528
    ds_read_b128 v[116:119], v20 offset:28928
    v_exp_f32 v165, v165
    v_cvt_pk_bf16_f32 v65, v162, v163
    v_exp_f32 v166, v166
    v_exp_f32 v167, v167
    v_cvt_pk_bf16_f32 v66, v164, v165
    v_exp_f32 v168, v168
    v_mfma_f32_32x32x16_bf16 v[144:159], v[120:123], v[72:75], v[144:159]
    s_bitcmp1_b32 s54, 3
    v_exp_f32 v169, v169
    v_cvt_pk_bf16_f32 v67, v166, v167
    v_exp_f32 v170, v170
    v_exp_f32 v171, v171
    v_cvt_pk_bf16_f32 v68, v168, v169
    v_exp_f32 v172, v172
    v_mfma_f32_32x32x16_bf16 v[144:159], v[124:127], v[76:79], v[144:159]
    s_waitcnt lgkmcnt(0)
    v_exp_f32 v173, v173
    v_cvt_pk_bf16_f32 v69, v170, v171
    v_exp_f32 v174, v174
    v_exp_f32 v175, v175
    v_cvt_pk_bf16_f32 v70, v172, v173
    v_cvt_pk_bf16_f32 v71, v174, v175
    s_cbranch_scc1 L_st3
L_bk3:
    v_mfma_f32_32x32x16_bf16 v[160:175], v[96:99], v[80:83], 0
    ds_read_b128 v[100:103], v19 offset:23552
    ds_read_b128 v[120:123], v20 offset:29696
    v_exp_f32 v176, v176
    v_exp_f32 v177, v177
    v_exp_f32 v178, v178
    v_exp_f32 v179, v179
    v_cvt_pk_bf16_f32 v72, v176, v177
    v_exp_f32 v180, v180
    v_mfma_f32_32x32x16_bf16 v[160:175], v[104:107], v[88:91], v[160:175]
    ds_read_b128 v[124:127], v20 offset:30464
    v_exp_f32 v181, v181
    v_cvt_pk_bf16_f32 v73, v178, v179
    v_exp_f32 v182, v182
    v_exp_f32 v183, v183
    v_cvt_pk_bf16_f32 v74, v180, v181
    v_exp_f32 v184, v184
    v_mfma_f32_32x32x16_bf16 v[128:143], v[112:115], v[64:67], v[128:143]
    v_exp_f32 v185, v185
    v_cvt_pk_bf16_f32 v75, v182, v183
    v_exp_f32 v186, v186
    v_exp_f32 v187, v187
    v_cvt_pk_bf16_f32 v76, v184, v185
    v_exp_f32 v188, v188
    v_mfma_f32_32x32x16_bf16 v[128:143], v[116:119], v[68:71], v[128:143]
    s_waitcnt lgkmcnt(0)
    ds_read_b32 v28, v22 offset:8
    v_exp_f32 v189, v189
    v_cvt_pk_bf16_f32 v77, v186, v187
    v_exp_f32 v190, v190
    v_exp_f32 v191, v191
    v_cvt_pk_bf16_f32 v78, v188, v189
    v_cvt_pk_bf16_f32 v79, v190, v191
    v_mfma_f32_32x32x16_bf16 v[176:191], v[100:103], v[84:87], 0
    ds_read_b128 v[96:99], v19 offset:16896
    ds_read_b128 v[112:115], v20 offset:22528
    v_exp_f32 v160, v160
    v_exp_f32 v161, v161
    v_exp_f32 v162, v162
    v_exp_f32 v163, v163
    v_cvt_pk_bf16_f32 v64, v160, v161
    v_exp_f32 v164, v164
    v_mfma_f32_32x32x16_bf16 v[176:191], v[104:107], v[92:95], v[176:191]
    ds_read_b64 v[104:105], v21 offset:16896
    ds_read_b128 v[116:119], v20 offset:23296
    v_exp_f32 v165, v165
    v_cvt_pk_bf16_f32 v65, v162, v163
    v_exp_f32 v166, v166
    v_exp_f32 v167, v167
    v_cvt_pk_bf16_f32 v66, v164, v165
    v_exp_f32 v168, v168
    v_mfma_f32_32x32x16_bf16 v[144:159], v[120:123], v[72:75], v[144:159]
    s_bitcmp1_b32 s54, 4
    v_exp_f32 v169, v169
    v_cvt_pk_bf16_f32 v67, v166, v167
    v_exp_f32 v170, v170
    v_exp_f32 v171, v171
    v_cvt_pk_bf16_f32 v68, v168, v169
    v_exp_f32 v172, v172
    v_mfma_f32_32x32x16_bf16 v[144:159], v[124:127], v[76:79], v[144:159]
    s_waitcnt lgkmcnt(0)
    v_exp_f32 v173, v173
    v_cvt_pk_bf16_f32 v69, v170, v171
    v_exp_f32 v174, v174
    v_exp_f32 v175, v175
    v_cvt_pk_bf16_f32 v70, v172, v173
    v_cvt_pk_bf16_f32 v71, v174, v175
    s_cbranch_scc1 L_st4
L_bk4:
    v_mfma_f32_32x32x16_bf16 v[160:175], v[96:99], v[80:83], 0
    ds_read_b128 v[100:103], v19 offset:17920
    ds_read_b128 v[120:123], v20 offset:24064
    v_exp_f32 v176, v176
    v_exp_f32 v177, v177
    v_exp_f32 v178, v178
    v_exp_f32 v179, v179
    v_cvt_pk_bf16_f32 v72, v176, v177
    v_exp_f32 v180, v180
    v_mfma_f32_32x32x16_bf16 v[160:175], v[104:107], v[88:91], v[160:175]
    ds_read_b128 v[124:127], v20 offset:24832
    v_exp_f32 v181, v181
    v_cvt_pk_bf16_f32 v73, v178, v179
    v_exp_f32 v182, v182
    v_exp_f32 v183, v183
    v_cvt_pk_bf16_f32 v74, v180, v181
    v_exp_f32 v184, v184
    v_mfma_f32_32x32x16_bf16 v[128:143], v[112:115], v[64:67], v[128:143]
    v_exp_f32 v185, v185
    v_cvt_pk_bf16_f32 v75, v182, v183
    v_exp_f32 v186, v186
    v_exp_f32 v187, v187
    v_cvt_pk_bf16_f32 v76, v184, v185
    v_exp_f32 v188, v188
    v_mfma_f32_32x32x16_bf16 v[128:143], v[116:119], v[68:71], v[128:143]
    s_waitcnt lgkmcnt(0)
    ds_read_b32 v28, v22 offset:8
    v_exp_f32 v189, v189
    v_cvt_pk_bf16_f32 v77, v186, v187
    v_exp_f32 v190, v190
    v_exp_f32 v191, v191
    v_cvt_pk_bf16_f32 v78, v188, v189
    v_cvt_pk_bf16_f32 v79, v190, v191
    v_mfma_f32_32x32x16_bf16 v[176:191], v[100:103], v[84:87], 0
    ds_read_b128 v[96:99], v19 offset:11264
    ds_read_b128 v[112:115], v20 offset:16896
    v_exp_f32 v160, v160
    v_exp_f32 v161, v161
    v_exp_f32 v162, v162
    v_exp_f32 v163, v163
    v_cvt_pk_bf16_f32 v64, v160, v161
    v_exp_f32 v164, v164
    v_mfma_f32_32x32x16_bf16 v[176:191], v[104:107], v[92:95], v[176:191]
    ds_read_b64 v[104:105], v21 offset:11264
    ds_read_b128 v[116:119], v20 offset:17664
    v_exp_f32 v165, v165
    v_cvt_pk_bf16_f32 v65, v162, v163
    v_exp_f32 v166, v166
    v_exp_f32 v167, v167
    v_cvt_pk_bf16_f32 v66, v164, v165
    v_exp_f32 v168, v168
    v_mfma_f32_32x32x16_bf16 v[144:159], v[120:123], v[72:75], v[144:159]
    s_bitcmp1_b32 s54, 5
    v_exp_f32 v169, v169
    v_cvt_pk_bf16_f32 v67, v166, v167
    v_exp_f32 v170, v170
    v_exp_f32 v171, v171
    v_cvt_pk_bf16_f32 v68, v168, v169
    v_exp_f32 v172, v172
    v_mfma_f32_32x32x16_bf16 v[144:159], v[124:127], v[76:79], v[144:159]
    s_waitcnt lgkmcnt(0)
    v_exp_f32 v173, v173
    v_cvt_pk_bf16_f32 v69, v170, v171
    v_exp_f32 v174, v174
    v_exp_f32 v175, v175
    v_cvt_pk_bf16_f32 v70, v172, v173
    v_cvt_pk_bf16_f32 v71, v174, v175
    s_cbranch_scc1 L_st5
L_bk5:
    v_mfma_f32_32x32x16_bf16 v[160:175], v[96:99], v[80:83], 0
    ds_read_b128 v[100:103], v19 offset:12288
    ds_read_b128 v[120:123], v20 offset:18432
    v_exp_f32 v176, v176
    v_exp_f32 v177, v177
    v_exp_f32 v178, v178
    v_exp_f32 v179, v179
    v_cvt_pk_bf16_f32 v72, v176, v177
    v_exp_f32 v180, v180
    v_mfma_f32_32x32x16_bf16 v[160:175], v[104:107], v[88:91], v[160:175]
    ds_read_b128 v[124:127], v20 offset:19200
    v_exp_f32 v181, v181
    v_cvt_pk_bf16_f32 v73, v178, v179
    v_exp_f32 v182, v182
    v_exp_f32 v183, v183
    v_cvt_pk_bf16_f32 v74, v180, v181
    v_exp_f32 v184, v184
    v_mfma_f32_32x32x16_bf16 v[128:143], v[112:115], v[64:67], v[128:143]
    v_exp_f32 v185, v185
    v_cvt_pk_bf16_f32 v75, v182, v183
    v_exp_f32 v186, v186
    v_exp_f32 v187, v187
    v_cvt_pk_bf16_f32 v76, v184, v185
    v_exp_f32 v188, v188
    v_mfma_f32_32x32x16_bf16 v[128:143], v[116:119], v[68:71], v[128:143]
    s_waitcnt lgkmcnt(0)
    ds_read_b32 v28, v22 offset:8
    v_exp_f32 v189, v189
    v_cvt_pk_bf16_f32 v77, v186, v187
    v_exp_f32 v190, v190
    v_exp_f32 v191, v191
    v_cvt_pk_bf16_f32 v78, v188, v189
    v_cvt_pk_bf16_f32 v79, v190, v191
    v_mfma_f32_32x32x16_bf16 v[176:191], v[100:103], v[84:87], 0
    ds_read_b128 v[96:99], v19 offset:5632
    ds_read_b128 v[112:115], v20 offset:11264
    v_exp_f32 v160, v160
    v_exp_f32 v161, v161
    v_exp_f32 v162, v162
    v_exp_f32 v163, v163
    v_cvt_pk_bf16_f32 v64, v160, v161
    v_exp_f32 v164, v164
    v_mfma_f32_32x32x16_bf16 v[176:191], v[104:107], v[92:95], v[176:191]
    ds_read_b64 v[104:105], v21 offset:5632
    ds_read_b128 v[116:119], v20 offset:12032
    v_exp_f32 v165, v165
    v_cvt_pk_bf16_f32 v65, v162, v163
    v_exp_f32 v166, v166
    v_exp_f32 v167, v167
    v_cvt_pk_bf16_f32 v66, v164, v165
    v_exp_f32 v168, v168
    v_mfma_f32_32x32x16_bf16 v[144:159], v[120:123], v[72:75], v[144:159]
    s_bitcmp1_b32 s54, 6
    v_exp_f32 v169, v169
    v_cvt_pk_bf16_f32 v67, v166, v167
    v_exp_f32 v170, v170
    v_exp_f32 v171, v171
    v_cvt_pk_bf16_f32 v68, v168, v169
    v_exp_f32 v172, v172
    v_mfma_f32_32x32x16_bf16 v[144:159], v[124:127], v[76:79], v[144:159]
    s_waitcnt lgkmcnt(0)
    v_exp_f32 v173, v173
    v_cvt_pk_bf16_f32 v69, v170, v171
    v_exp_f32 v174, v174
    v_exp_f32 v175, v175
    v_cvt_pk_bf16_f32 v70, v172, v173
    v_cvt_pk_bf16_f32 v71, v174, v175
    s_cbranch_scc1 L_st6
L_bk6:
    v_mfma_f32_32x32x16_bf16 v[160:175], v[96:99], v[80:83], 0
    ds_read_b128 v[100:103], v19 offset:6656
    ds_read_b128 v[120:123], v20 offset:12800
    v_exp_f32 v176, v176
    v_exp_f32 v177, v177
    v_exp_f32 v178, v178
    v_exp_f32 v179, v179
    v_cvt_pk_bf16_f32 v72, v176, v177
    v_exp_f32 v180, v180
    v_mfma_f32_32x32x16_bf16 v[160:175], v[104:107], v[88:91], v[160:175]
    ds_read_b128 v[124:127], v20 offset:13568
    v_exp_f32 v181, v181
    v_cvt_pk_bf16_f32 v73, v178, v179
    v_exp_f32 v182, v182
    v_exp_f32 v183, v183
    v_cvt_pk_bf16_f32 v74, v180, v181
    v_exp_f32 v184, v184
    v_mfma_f32_32x32x16_bf16 v[128:143], v[112:115], v[64:67], v[128:143]
    v_exp_f32 v185, v185
    v_cvt_pk_bf16_f32 v75, v182, v183
    v_exp_f32 v186, v186
    v_exp_f32 v187, v187
    v_cvt_pk_bf16_f32 v76, v184, v185
    v_exp_f32 v188, v188
    v_mfma_f32_32x32x16_bf16 v[128:143], v[116:119], v[68:71], v[128:143]
    s_waitcnt lgkmcnt(0)
    ds_read_b32 v28, v22 offset:8
    v_exp_f32 v189, v189
    v_cvt_pk_bf16_f32 v77, v186, v187
    v_exp_f32 v190, v190
    v_exp_f32 v191, v191
    v_cvt_pk_bf16_f32 v78, v188, v189
    v_cvt_pk_bf16_f32 v79, v190, v191
    v_mfma_f32_32x32x16_bf16 v[176:191], v[100:103], v[84:87], 0
    ds_read_b128 v[96:99], v19 offset:0
    ds_read_b128 v[112:115], v20 offset:5632
    v_exp_f32 v160, v160
    v_exp_f32 v161, v161
    v_exp_f32 v162, v162
    v_exp_f32 v163, v163
    v_cvt_pk_bf16_f32 v64, v160, v161
    v_exp_f32 v164, v164
    v_mfma_f32_32x32x16_bf16 v[176:191], v[104:107], v[92:95], v[176:191]
    ds_read_b64 v[104:105], v21 offset:0
    ds_read_b128 v[116:119], v20 offset:6400
    v_exp_f32 v165, v165
    v_cvt_pk_bf16_f32 v65, v162, v163
    v_exp_f32 v166, v166
    v_exp_f32 v167, v167
    v_cvt_pk_bf16_f32 v66, v164, v165
    v_exp_f32 v168, v168
    v_mfma_f32_32x32x16_bf16 v[144:159], v[120:123], v[72:75], v[144:159]
    s_bitcmp1_b32 s54, 7
    v_exp_f32 v169, v169
    v_cvt_pk_bf16_f32 v67, v166, v167
    v_exp_f32 v170, v170
    v_exp_f32 v171, v171
    v_cvt_pk_bf16_f32 v68, v168, v169
    v_exp_f32 v172, v172
    v_mfma_f32_32x32x16_bf16 v[144:159], v[124:127], v[76:79], v[144:159]
    s_waitcnt lgkmcnt(0)
    v_exp_f32 v173, v173
    v_cvt_pk_bf16_f32 v69, v170, v171
    v_exp_f32 v174, v174
    v_exp_f32 v175, v175
    v_cvt_pk_bf16_f32 v70, v172, v173
    v_cvt_pk_bf16_f32 v71, v174, v175
    s_cbranch_scc1 L_st7
L_bk7:
    v_mfma_f32_32x32x16_bf16 v[160:175], v[96:99], v[80:83], v[48:63]
    ds_read_b128 v[100:103], v19 offset:1024
    ds_read_b128 v[120:123], v20 offset:7168
    v_exp_f32 v176, v176
    v_exp_f32 v177, v177
    v_exp_f32 v178, v178
    v_exp_f32 v179, v179
    v_cvt_pk_bf16_f32 v72, v176, v177
    v_exp_f32 v180, v180
    v_mfma_f32_32x32x16_bf16 v[160:175], v[104:107], v[88:91], v[160:175]
    ds_read_b128 v[124:127], v20 offset:7936
    v_exp_f32 v181, v181
    v_cvt_pk_bf16_f32 v73, v178, v179
    v_exp_f32 v182, v182
    v_exp_f32 v183, v183
    v_cvt_pk_bf16_f32 v74, v180, v181
    v_exp_f32 v184, v184
    v_mfma_f32_32x32x16_bf16 v[128:143], v[112:115], v[64:67], v[128:143]
    v_exp_f32 v185, v185
    v_cvt_pk_bf16_f32 v75, v182, v183
    v_exp_f32 v186, v186
    v_exp_f32 v187, v187
    v_cvt_pk_bf16_f32 v76, v184, v185
    v_exp_f32 v188, v188
    v_mfma_f32_32x32x16_bf16 v[128:143], v[116:119], v[68:71], v[128:143]
    s_waitcnt lgkmcnt(0)
    v_exp_f32 v189, v189
    v_cvt_pk_bf16_f32 v77, v186, v187
    v_exp_f32 v190, v190
    v_exp_f32 v191, v191
    v_cvt_pk_bf16_f32 v78, v188, v189
    v_cvt_pk_bf16_f32 v79, v190, v191
    v_mfma_f32_32x32x16_bf16 v[176:191], v[100:103], v[84:87], v[48:63]
    ds_read_b128 v[112:115], v20 offset:0
    v_exp_f32 v160, v160
    v_exp_f32 v161, v161
    v_exp_f32 v162, v162
    v_exp_f32 v163, v163
    v_cvt_pk_bf16_f32 v64, v160, v161
    v_exp_f32 v164, v164
    v_mfma_f32_32x32x16_bf16 v[176:191], v[104:107], v[92:95], v[176:191]
    ds_read_b128 v[116:119], v20 offset:768
    v_exp_f32 v165, v165
    v_cvt_pk_bf16_f32 v65, v162, v163
    v_exp_f32 v166, v166
    v_exp_f32 v167, v167
    v_cvt_pk_bf16_f32 v66, v164, v165
    v_exp_f32 v168, v168
    v_mfma_f32_32x32x16_bf16 v[144:159], v[120:123], v[72:75], v[144:159]
    v_exp_f32 v169, v169
    v_cvt_pk_bf16_f32 v67, v166, v167
    v_exp_f32 v170, v170
    v_exp_f32 v171, v171
    v_cvt_pk_bf16_f32 v68, v168, v169
    v_exp_f32 v172, v172
    v_mfma_f32_32x32x16_bf16 v[144:159], v[124:127], v[76:79], v[144:159]
    s_waitcnt lgkmcnt(0)
    v_exp_f32 v173, v173
    v_cvt_pk_bf16_f32 v69, v170, v171
    v_exp_f32 v174, v174
    v_exp_f32 v175, v175
    v_cvt_pk_bf16_f32 v70, v172, v173
    v_cvt_pk_bf16_f32 v71, v174, v175
L_bk8:
    v_exp_f32 v176, v176
    v_exp_f32 v177, v177
    v_mfma_f32_32x32x16_bf16 v[128:143], v[112:115], v[64:67], v[128:143]
    ds_read_b128 v[120:123], v20 offset:1536
    ds_read_b128 v[124:127], v20 offset:2304
    v_exp_f32 v178, v178
    v_exp_f32 v179, v179
    v_cvt_pk_bf16_f32 v72, v176, v177
    v_exp_f32 v180, v180
    v_exp_f32 v181, v181
    v_cvt_pk_bf16_f32 v73, v178, v179
    v_mfma_f32_32x32x16_bf16 v[128:143], v[116:119], v[68:71], v[128:143]
    v_exp_f32 v182, v182
    v_exp_f32 v183, v183
    v_cvt_pk_bf16_f32 v74, v180, v181
    v_exp_f32 v184, v184
    v_exp_f32 v185, v185
    v_cvt_pk_bf16_f32 v75, v182, v183
    v_exp_f32 v186, v186
    v_exp_f32 v187, v187
    v_cvt_pk_bf16_f32 v76, v184, v185
    s_waitcnt lgkmcnt(0)
    v_mfma_f32_32x32x16_bf16 v[144:159], v[120:123], v[72:75], v[144:159]
    s_mov_b32 s4, 671088640
    v_exp_f32 v188, v188
    v_exp_f32 v189, v189
    v_cvt_pk_bf16_f32 v77, v186, v187
    v_exp_f32 v190, v190
    v_exp_f32 v191, v191
    v_cvt_pk_bf16_f32 v78, v188, v189
    v_cvt_pk_bf16_f32 v79, v190, v191
    v_rcp_f32 v2, v140
    s_nop 0
    v_mfma_f32_32x32x16_bf16 v[144:159], v[124:127], v[76:79], v[144:159]
L_fin:
    v_subrev_u32 v6, 729808896, v140
    v_pk_mul_f32 v[128:129], v[128:129], v[2:3] op_sel_hi:[1,0]
    v_pk_mul_f32 v[130:131], v[130:131], v[2:3] op_sel_hi:[1,0]
    v_pk_mul_f32 v[132:133], v[132:133], v[2:3] op_sel_hi:[1,0]
    v_pk_mul_f32 v[134:135], v[134:135], v[2:3] op_sel_hi:[1,0]
    v_cvt_pk_bf16_f32 v64, v128, v129
    v_cvt_pk_bf16_f32 v65, v130, v131
    v_cvt_pk_bf16_f32 v66, v132, v133
    v_cvt_pk_bf16_f32 v67, v134, v135
    buffer_store_dwordx4 v[64:67], v16, s[40:43], s56 offen sc1
    v_pk_mul_f32 v[136:137], v[136:137], v[2:3] op_sel_hi:[1,0]
    v_pk_mul_f32 v[138:139], v[138:139], v[2:3] op_sel_hi:[1,0]
    v_cvt_pk_bf16_f32 v72, v136, v137
    v_cvt_pk_bf16_f32 v73, v138, v139
    v_rcp_f32 v2, v156
    v_subrev_u32 v7, 729808896, v156
    v_max_u32 v6, v6, v7
    v_cmp_lt_u32 vcc, s4, v6
    v_pk_mul_f32 v[144:145], v[144:145], v[2:3] op_sel_hi:[1,0]
    v_pk_mul_f32 v[146:147], v[146:147], v[2:3] op_sel_hi:[1,0]
    v_pk_mul_f32 v[148:149], v[148:149], v[2:3] op_sel_hi:[1,0]
    v_pk_mul_f32 v[150:151], v[150:151], v[2:3] op_sel_hi:[1,0]
    s_cbranch_vccnz L_slow
    v_cvt_pk_bf16_f32 v68, v144, v145
    v_cvt_pk_bf16_f32 v69, v146, v147
    v_cvt_pk_bf16_f32 v70, v148, v149
    v_cvt_pk_bf16_f32 v71, v150, v151
    buffer_store_dwordx4 v[68:71], v16, s[40:43], s56 offen offset:1536 sc1
    v_pk_mul_f32 v[152:153], v[152:153], v[2:3] op_sel_hi:[1,0]
    v_pk_mul_f32 v[154:155], v[154:155], v[2:3] op_sel_hi:[1,0]
    v_cvt_pk_bf16_f32 v74, v152, v153
    v_cvt_pk_bf16_f32 v75, v154, v155
    s_mov_b32 exec_hi, 0
    buffer_store_dwordx4 v[72:75], v16, s[40:43], s56 offen offset:1024 sc1
    s_mov_b64 exec, 1
    ds_add_u32 v22, v23 offset:4
    s_setprio 1
    s_cmp_ge_u32 s48, 4
    s_cbranch_scc1 L_hi3
    s_mov_b64 exec, 0xff
    s_waitcnt vmcnt(0)
    buffer_store_dword v23, v25, s[40:43], s57 offen sc1
    s_mov_b64 exec, -1
    s_call_b64 s[22:23], L_wpre
    s_mov_b32 s4, 0
    s_branch L_pl_o
L_pw_o:
    s_sleep 2
L_pl_o:
    s_load_dwordx16 s[12:27], s[40:41], s58 glc
L_pc_o:
    s_add_u32 s4, s4, 1
    s_cmp_gt_u32 s4, 65536
    s_waitcnt lgkmcnt(0)
    s_cbranch_scc1 L_px_o
    s_and_b64 s[12:13], s[12:13], s[20:21]
    s_and_b64 s[14:15], s[14:15], s[22:23]
    s_and_b64 s[16:17], s[16:17], s[24:25]
    s_and_b64 s[18:19], s[18:19], s[26:27]
    s_and_b64 s[12:13], s[12:13], s[16:17]
    s_and_b64 s[14:15], s[14:15], s[18:19]
    s_and_b64 s[12:13], s[12:13], s[14:15]
    s_and_b32 s12, s12, s13
    s_cbranch_scc0 L_pw_o
L_px_o:
    buffer_load_dwordx4 v[156:159], v8, s[40:43], s59 offen offset:0 sc1
    buffer_load_dwordx4 v[160:163], v8, s[40:43], s59 offen offset:2048 sc1
    s_addk_i32 s59, 4096
    s_cmpk_eq_u32 s59, 40960
    s_cselect_b32 s59, 0, s59
    buffer_load_dwordx4 v[164:167], v8, s[40:43], s59 offen offset:0 sc1
    buffer_load_dwordx4 v[168:171], v8, s[40:43], s59 offen offset:2048 sc1
    s_addk_i32 s59, 4096
    s_cmpk_eq_u32 s59, 40960
    s_cselect_b32 s59, 0, s59
    buffer_load_dwordx4 v[172:175], v8, s[40:43], s59 offen offset:0 sc1
    buffer_load_dwordx4 v[176:179], v8, s[40:43], s59 offen offset:2048 sc1
    s_addk_i32 s59, 4096
    s_cmpk_eq_u32 s59, 40960
    s_cselect_b32 s59, 0, s59
    buffer_load_dwordx4 v[180:183], v8, s[40:43], s59 offen offset:0 sc1
    s_cmp_lt_u32 s48, 4
    s_cbranch_scc1 L_nopre2
    s_call_b64 s[22:23], L_wpre
L_nopre2:
    s_waitcnt vmcnt(6) lgkmcnt(0)
    v_mfma_f32_16x16x32_bf16 v[236:239], v[16:19], v[156:159], 0
    buffer_load_dwordx4 v[184:187], v8, s[40:43], s59 offen offset:2048 sc1
    v_mfma_f32_16x16x32_bf16 v[240:243], v[20:23], v[156:159], 0
    s_addk_i32 s59, 4096
    v_mfma_f32_16x16x32_bf16 v[244:247], v[24:27], v[156:159], 0
    s_cmpk_eq_u32 s59, 40960
    v_mfma_f32_16x16x32_bf16 v[248:251], v[28:31], v[156:159], 0
    s_cselect_b32 s59, 0, s59
    v_mfma_f32_16x16x32_bf16 v[252:255], v[32:35], v[156:159], 0
    s_waitcnt vmcnt(6) lgkmcnt(0)
    v_mfma_f32_16x16x32_bf16 v[236:239], v[36:39], v[160:163], v[236:239]
    buffer_load_dwordx4 v[188:191], v8, s[40:43], s59 offen offset:0 sc1
    ds_read_b64_tr_b16 v[16:17], v9 offset:35840
    ds_read_b64_tr_b16 v[18:19], v10 offset:35840
    v_mfma_f32_16x16x32_bf16 v[240:243], v[40:43], v[160:163], v[240:243]
    ds_read_b64_tr_b16 v[20:21], v9 offset:35848
    ds_read_b64_tr_b16 v[22:23], v10 offset:35848
    v_mfma_f32_16x16x32_bf16 v[244:247], v[44:47], v[160:163], v[244:247]
    ds_read_b64_tr_b16 v[24:25], v9 offset:35856
    v_mfma_f32_16x16x32_bf16 v[248:251], v[48:51], v[160:163], v[248:251]
    ds_read_b64_tr_b16 v[26:27], v10 offset:35856
    ds_read_b64_tr_b16 v[28:29], v9 offset:35864
    v_mfma_f32_16x16x32_bf16 v[252:255], v[52:55], v[160:163], v[252:255]
    ds_read_b64_tr_b16 v[30:31], v10 offset:35864
    s_waitcnt vmcnt(6) lgkmcnt(8)
    v_mfma_f32_16x16x32_bf16 v[236:239], v[56:59], v[164:167], v[236:239]
    buffer_load_dwordx4 v[192:195], v8, s[40:43], s59 offen offset:2048 sc1
    ds_read_b64_tr_b16 v[32:33], v9 offset:35872
    ds_read_b64_tr_b16 v[34:35], v10 offset:35872
    v_mfma_f32_16x16x32_bf16 v[240:243], v[60:63], v[164:167], v[240:243]
    s_addk_i32 s59, 4096
    ds_read_b64_tr_b16 v[36:37], v9 offset:40960
    ds_read_b64_tr_b16 v[38:39], v10 offset:40960
    v_mfma_f32_16x16x32_bf16 v[244:247], v[64:67], v[164:167], v[244:247]
    s_cmpk_eq_u32 s59, 40960
    ds_read_b64_tr_b16 v[40:41], v9 offset:40968
    v_mfma_f32_16x16x32_bf16 v[248:251], v[68:71], v[164:167], v[248:251]
    s_cselect_b32 s59, 0, s59
    ds_read_b64_tr_b16 v[42:43], v10 offset:40968
    ds_read_b64_tr_b16 v[44:45], v9 offset:40976
    v_mfma_f32_16x16x32_bf16 v[252:255], v[72:75], v[164:167], v[252:255]
    ds_read_b64_tr_b16 v[46:47], v10 offset:40976
    s_waitcnt vmcnt(6) lgkmcnt(8)
    v_mfma_f32_16x16x32_bf16 v[236:239], v[76:79], v[168:171], v[236:239]
    buffer_load_dwordx4 v[196:199], v8, s[40:43], s59 offen offset:0 sc1
    ds_read_b64_tr_b16 v[48:49], v9 offset:40984
    ds_read_b64_tr_b16 v[50:51], v10 offset:40984
    v_mfma_f32_16x16x32_bf16 v[240:243], v[80:83], v[168:171], v[240:243]
    ds_read_b64_tr_b16 v[52:53], v9 offset:40992
    ds_read_b64_tr_b16 v[54:55], v10 offset:40992
    v_mfma_f32_16x16x32_bf16 v[244:247], v[84:87], v[168:171], v[244:247]
    ds_read_b64_tr_b16 v[56:57], v9 offset:46080
    v_mfma_f32_16x16x32_bf16 v[248:251], v[88:91], v[168:171], v[248:251]
    ds_read_b64_tr_b16 v[58:59], v10 offset:46080
    ds_read_b64_tr_b16 v[60:61], v9 offset:46088
    v_mfma_f32_16x16x32_bf16 v[252:255], v[92:95], v[168:171], v[252:255]
    ds_read_b64_tr_b16 v[62:63], v10 offset:46088
    s_waitcnt vmcnt(6) lgkmcnt(8)
    v_mfma_f32_16x16x32_bf16 v[236:239], v[96:99], v[172:175], v[236:239]
    buffer_load_dwordx4 v[200:203], v8, s[40:43], s59 offen offset:2048 sc1
    ds_read_b64_tr_b16 v[64:65], v9 offset:46096
    ds_read_b64_tr_b16 v[66:67], v10 offset:46096
    v_mfma_f32_16x16x32_bf16 v[240:243], v[100:103], v[172:175], v[240:243]
    s_addk_i32 s59, 4096
    ds_read_b64_tr_b16 v[68:69], v9 offset:46104
    ds_read_b64_tr_b16 v[70:71], v10 offset:46104
    v_mfma_f32_16x16x32_bf16 v[244:247], v[104:107], v[172:175], v[244:247]
    s_cmpk_eq_u32 s59, 40960
    ds_read_b64_tr_b16 v[72:73], v9 offset:46112
    v_mfma_f32_16x16x32_bf16 v[248:251], v[108:111], v[172:175], v[248:251]
    s_cselect_b32 s59, 0, s59
    ds_read_b64_tr_b16 v[74:75], v10 offset:46112
    v_add_u32 v9, 51200, v9
    v_add_u32 v10, 51200, v10
    ds_read_b64_tr_b16 v[76:77], v9 offset:0
    v_mfma_f32_16x16x32_bf16 v[252:255], v[112:115], v[172:175], v[252:255]
    ds_read_b64_tr_b16 v[78:79], v10 offset:0
    s_waitcnt vmcnt(6) lgkmcnt(8)
    v_mfma_f32_16x16x32_bf16 v[236:239], v[116:119], v[176:179], v[236:239]
    buffer_load_dwordx4 v[204:207], v8, s[40:43], s59 offen offset:0 sc1
    ds_read_b64_tr_b16 v[80:81], v9 offset:8
    ds_read_b64_tr_b16 v[82:83], v10 offset:8
    v_mfma_f32_16x16x32_bf16 v[240:243], v[120:123], v[176:179], v[240:243]
    ds_read_b64_tr_b16 v[84:85], v9 offset:16
    ds_read_b64_tr_b16 v[86:87], v10 offset:16
    v_mfma_f32_16x16x32_bf16 v[244:247], v[124:127], v[176:179], v[244:247]
    ds_read_b64_tr_b16 v[88:89], v9 offset:24
    v_mfma_f32_16x16x32_bf16 v[248:251], v[128:131], v[176:179], v[248:251]
    ds_read_b64_tr_b16 v[90:91], v10 offset:24
    ds_read_b64_tr_b16 v[92:93], v9 offset:32
    v_mfma_f32_16x16x32_bf16 v[252:255], v[132:135], v[176:179], v[252:255]
    ds_read_b64_tr_b16 v[94:95], v10 offset:32
    s_waitcnt vmcnt(6) lgkmcnt(8)
    v_mfma_f32_16x16x32_bf16 v[236:239], v[136:139], v[180:183], v[236:239]
    buffer_load_dwordx4 v[208:211], v8, s[40:43], s59 offen offset:2048 sc1
    ds_read_b64_tr_b16 v[96:97], v9 offset:5120
    ds_read_b64_tr_b16 v[98:99], v10 offset:5120
    v_mfma_f32_16x16x32_bf16 v[240:243], v[140:143], v[180:183], v[240:243]
    s_addk_i32 s59, 4096
    ds_read_b64_tr_b16 v[100:101], v9 offset:5128
    ds_read_b64_tr_b16 v[102:103], v10 offset:5128
    v_mfma_f32_16x16x32_bf16 v[244:247], v[144:147], v[180:183], v[244:247]
    s_cmpk_eq_u32 s59, 40960
    ds_read_b64_tr_b16 v[104:105], v9 offset:5136
    v_mfma_f32_16x16x32_bf16 v[248:251], v[148:151], v[180:183], v[248:251]
    s_cselect_b32 s59, 0, s59
    ds_read_b64_tr_b16 v[106:107], v10 offset:5136
    ds_read_b64_tr_b16 v[108:109], v9 offset:5144
    v_mfma_f32_16x16x32_bf16 v[252:255], v[152:155], v[180:183], v[252:255]
    ds_read_b64_tr_b16 v[110:111], v10 offset:5144
    s_waitcnt vmcnt(6) lgkmcnt(8)
    v_mfma_f32_16x16x32_bf16 v[236:239], v[16:19], v[184:187], v[236:239]
    buffer_load_dwordx4 v[212:215], v8, s[40:43], s59 offen offset:0 sc1
    ds_read_b64_tr_b16 v[112:113], v9 offset:5152
    ds_read_b64_tr_b16 v[114:115], v10 offset:5152
    v_mfma_f32_16x16x32_bf16 v[240:243], v[20:23], v[184:187], v[240:243]
    ds_read_b64_tr_b16 v[116:117], v9 offset:10240
    ds_read_b64_tr_b16 v[118:119], v10 offset:10240
    v_mfma_f32_16x16x32_bf16 v[244:247], v[24:27], v[184:187], v[244:247]
    ds_read_b64_tr_b16 v[120:121], v9 offset:10248
    v_mfma_f32_16x16x32_bf16 v[248:251], v[28:31], v[184:187], v[248:251]
    ds_read_b64_tr_b16 v[122:123], v10 offset:10248
    ds_read_b64_tr_b16 v[124:125], v9 offset:10256
    v_mfma_f32_16x16x32_bf16 v[252:255], v[32:35], v[184:187], v[252:255]
    ds_read_b64_tr_b16 v[126:127], v10 offset:10256
    s_waitcnt vmcnt(6) lgkmcnt(8)
    v_mfma_f32_16x16x32_bf16 v[236:239], v[36:39], v[188:191], v[236:239]
    buffer_load_dwordx4 v[216:219], v8, s[40:43], s59 offen offset:2048 sc1
    ds_read_b64_tr_b16 v[128:129], v9 offset:10264
    ds_read_b64_tr_b16 v[130:131], v10 offset:10264
    v_mfma_f32_16x16x32_bf16 v[240:243], v[40:43], v[188:191], v[240:243]
    s_addk_i32 s59, 4096
    ds_read_b64_tr_b16 v[132:133], v9 offset:10272
    ds_read_b64_tr_b16 v[134:135], v10 offset:10272
    v_mfma_f32_16x16x32_bf16 v[244:247], v[44:47], v[188:191], v[244:247]
    s_cmpk_eq_u32 s59, 40960
    ds_read_b64_tr_b16 v[136:137], v9 offset:15360
    v_mfma_f32_16x16x32_bf16 v[248:251], v[48:51], v[188:191], v[248:251]
    s_cselect_b32 s59, 0, s59
    ds_read_b64_tr_b16 v[138:139], v10 offset:15360
    ds_read_b64_tr_b16 v[140:141], v9 offset:15368
    v_mfma_f32_16x16x32_bf16 v[252:255], v[52:55], v[188:191], v[252:255]
    ds_read_b64_tr_b16 v[142:143], v10 offset:15368
    s_waitcnt vmcnt(6) lgkmcnt(8)
    v_mfma_f32_16x16x32_bf16 v[236:239], v[56:59], v[192:195], v[236:239]
    buffer_load_dwordx4 v[220:223], v8, s[40:43], s59 offen offset:0 sc1
    ds_read_b64_tr_b16 v[144:145], v9 offset:15376
    ds_read_b64_tr_b16 v[146:147], v10 offset:15376
    v_mfma_f32_16x16x32_bf16 v[240:243], v[60:63], v[192:195], v[240:243]
    ds_read_b64_tr_b16 v[148:149], v9 offset:15384
    ds_read_b64_tr_b16 v[150:151], v10 offset:15384
    v_mfma_f32_16x16x32_bf16 v[244:247], v[64:67], v[192:195], v[244:247]
    ds_read_b64_tr_b16 v[152:153], v9 offset:15392
    v_mfma_f32_16x16x32_bf16 v[248:251], v[68:71], v[192:195], v[248:251]
    ds_read_b64_tr_b16 v[154:155], v10 offset:15392
    ds_read_b64_tr_b16 v[16:17], v9 offset:20480
    v_mfma_f32_16x16x32_bf16 v[252:255], v[72:75], v[192:195], v[252:255]
    ds_read_b64_tr_b16 v[18:19], v10 offset:20480
    s_waitcnt vmcnt(6) lgkmcnt(8)
    v_mfma_f32_16x16x32_bf16 v[236:239], v[76:79], v[196:199], v[236:239]
    buffer_load_dwordx4 v[224:227], v8, s[40:43], s59 offen offset:2048 sc1
    ds_read_b64_tr_b16 v[20:21], v9 offset:20488
    ds_read_b64_tr_b16 v[22:23], v10 offset:20488
    v_mfma_f32_16x16x32_bf16 v[240:243], v[80:83], v[196:199], v[240:243]
    s_addk_i32 s59, 4096
    ds_read_b64_tr_b16 v[24:25], v9 offset:20496
    ds_read_b64_tr_b16 v[26:27], v10 offset:20496
    v_mfma_f32_16x16x32_bf16 v[244:247], v[84:87], v[196:199], v[244:247]
    s_cmpk_eq_u32 s59, 40960
    ds_read_b64_tr_b16 v[28:29], v9 offset:20504
    v_mfma_f32_16x16x32_bf16 v[248:251], v[88:91], v[196:199], v[248:251]
    s_cselect_b32 s59, 0, s59
    ds_read_b64_tr_b16 v[30:31], v10 offset:20504
    ds_read_b64_tr_b16 v[32:33], v9 offset:20512
    v_mfma_f32_16x16x32_bf16 v[252:255], v[92:95], v[196:199], v[252:255]
    ds_read_b64_tr_b16 v[34:35], v10 offset:20512
    s_waitcnt vmcnt(6) lgkmcnt(8)
    v_mfma_f32_16x16x32_bf16 v[236:239], v[96:99], v[200:203], v[236:239]
    buffer_load_dwordx4 v[228:231], v8, s[40:43], s59 offen offset:0 sc1
    ds_read_b64_tr_b16 v[36:37], v9 offset:25600
    ds_read_b64_tr_b16 v[38:39], v10 offset:25600
    v_mfma_f32_16x16x32_bf16 v[240:243], v[100:103], v[200:203], v[240:243]
    ds_read_b64_tr_b16 v[40:41], v9 offset:25608
    ds_read_b64_tr_b16 v[42:43], v10 offset:25608
    v_mfma_f32_16x16x32_bf16 v[244:247], v[104:107], v[200:203], v[244:247]
    ds_read_b64_tr_b16 v[44:45], v9 offset:25616
    v_mfma_f32_16x16x32_bf16 v[248:251], v[108:111], v[200:203], v[248:251]
    ds_read_b64_tr_b16 v[46:47], v10 offset:25616
    ds_read_b64_tr_b16 v[48:49], v9 offset:25624
    v_mfma_f32_16x16x32_bf16 v[252:255], v[112:115], v[200:203], v[252:255]
    ds_read_b64_tr_b16 v[50:51], v10 offset:25624
    s_waitcnt vmcnt(6) lgkmcnt(8)
    v_mfma_f32_16x16x32_bf16 v[236:239], v[116:119], v[204:207], v[236:239]
    buffer_load_dwordx4 v[232:235], v8, s[40:43], s59 offen offset:2048 sc1
    ds_read_b64_tr_b16 v[52:53], v9 offset:25632
    ds_read_b64_tr_b16 v[54:55], v10 offset:25632
    v_mfma_f32_16x16x32_bf16 v[240:243], v[120:123], v[204:207], v[240:243]
    ds_read_b64_tr_b16 v[56:57], v9 offset:30720
    ds_read_b64_tr_b16 v[58:59], v10 offset:30720
    v_mfma_f32_16x16x32_bf16 v[244:247], v[124:127], v[204:207], v[244:247]
    ds_read_b64_tr_b16 v[60:61], v9 offset:30728
    v_mfma_f32_16x16x32_bf16 v[248:251], v[128:131], v[204:207], v[248:251]
    ds_read_b64_tr_b16 v[62:63], v10 offset:30728
    ds_read_b64_tr_b16 v[64:65], v9 offset:30736
    v_mfma_f32_16x16x32_bf16 v[252:255], v[132:135], v[204:207], v[252:255]
    ds_read_b64_tr_b16 v[66:67], v10 offset:30736
    s_waitcnt vmcnt(6) lgkmcnt(8)
    v_mfma_f32_16x16x32_bf16 v[236:239], v[136:139], v[208:211], v[236:239]
    ds_read_b64_tr_b16 v[68:69], v9 offset:30744
    ds_read_b64_tr_b16 v[70:71], v10 offset:30744
    v_mfma_f32_16x16x32_bf16 v[240:243], v[140:143], v[208:211], v[240:243]
    ds_read_b64_tr_b16 v[72:73], v9 offset:30752
    ds_read_b64_tr_b16 v[74:75], v10 offset:30752
    v_mfma_f32_16x16x32_bf16 v[244:247], v[144:147], v[208:211], v[244:247]
    ds_read_b64_tr_b16 v[76:77], v9 offset:35840
    v_mfma_f32_16x16x32_bf16 v[248:251], v[148:151], v[208:211], v[248:251]
    ds_read_b64_tr_b16 v[78:79], v10 offset:35840
    ds_read_b64_tr_b16 v[80:81], v9 offset:35848
    v_mfma_f32_16x16x32_bf16 v[252:255], v[152:155], v[208:211], v[252:255]
    ds_read_b64_tr_b16 v[82:83], v10 offset:35848
    s_waitcnt vmcnt(5) lgkmcnt(8)
    v_mfma_f32_16x16x32_bf16 v[236:239], v[16:19], v[212:215], v[236:239]
    ds_read_b64_tr_b16 v[84:85], v9 offset:35856
    ds_read_b64_tr_b16 v[86:87], v10 offset:35856
    v_mfma_f32_16x16x32_bf16 v[240:243], v[20:23], v[212:215], v[240:243]
    ds_read_b64_tr_b16 v[88:89], v9 offset:35864
    ds_read_b64_tr_b16 v[90:91], v10 offset:35864
    v_mfma_f32_16x16x32_bf16 v[244:247], v[24:27], v[212:215], v[244:247]
    ds_read_b64_tr_b16 v[92:93], v9 offset:35872
    v_mfma_f32_16x16x32_bf16 v[248:251], v[28:31], v[212:215], v[248:251]
    ds_read_b64_tr_b16 v[94:95], v10 offset:35872
    ds_read_b64_tr_b16 v[96:97], v9 offset:40960
    v_mfma_f32_16x16x32_bf16 v[252:255], v[32:35], v[212:215], v[252:255]
    ds_read_b64_tr_b16 v[98:99], v10 offset:40960
    s_waitcnt vmcnt(4) lgkmcnt(8)
    v_mfma_f32_16x16x32_bf16 v[236:239], v[36:39], v[216:219], v[236:239]
    ds_read_b64_tr_b16 v[100:101], v9 offset:40968
    ds_read_b64_tr_b16 v[102:103], v10 offset:40968
    v_mfma_f32_16x16x32_bf16 v[240:243], v[40:43], v[216:219], v[240:243]
    ds_read_b64_tr_b16 v[104:105], v9 offset:40976
    ds_read_b64_tr_b16 v[106:107], v10 offset:40976
    v_mfma_f32_16x16x32_bf16 v[244:247], v[44:47], v[216:219], v[244:247]
    ds_read_b64_tr_b16 v[108:109], v9 offset:40984
    v_mfma_f32_16x16x32_bf16 v[248:251], v[48:51], v[216:219], v[248:251]
    ds_read_b64_tr_b16 v[110:111], v10 offset:40984
    ds_read_b64_tr_b16 v[112:113], v9 offset:40992
    v_mfma_f32_16x16x32_bf16 v[252:255], v[52:55], v[216:219], v[252:255]
    ds_read_b64_tr_b16 v[114:115], v10 offset:40992
    s_waitcnt vmcnt(3) lgkmcnt(8)
    v_mfma_f32_16x16x32_bf16 v[236:239], v[56:59], v[220:223], v[236:239]
    ds_read_b64_tr_b16 v[116:117], v9 offset:46080
    ds_read_b64_tr_b16 v[118:119], v10 offset:46080
    v_mfma_f32_16x16x32_bf16 v[240:243], v[60:63], v[220:223], v[240:243]
    ds_read_b64_tr_b16 v[120:121], v9 offset:46088
    ds_read_b64_tr_b16 v[122:123], v10 offset:46088
    v_mfma_f32_16x16x32_bf16 v[244:247], v[64:67], v[220:223], v[244:247]
    ds_read_b64_tr_b16 v[124:125], v9 offset:46096
    v_mfma_f32_16x16x32_bf16 v[248:251], v[68:71], v[220:223], v[248:251]
    ds_read_b64_tr_b16 v[126:127], v10 offset:46096
    ds_read_b64_tr_b16 v[128:129], v9 offset:46104
    v_mfma_f32_16x16x32_bf16 v[252:255], v[72:75], v[220:223], v[252:255]
    ds_read_b64_tr_b16 v[130:131], v10 offset:46104
    s_waitcnt vmcnt(2) lgkmcnt(8)
    v_mfma_f32_16x16x32_bf16 v[236:239], v[76:79], v[224:227], v[236:239]
    ds_read_b64_tr_b16 v[132:133], v9 offset:46112
    v_mfma_f32_16x16x32_bf16 v[240:243], v[80:83], v[224:227], v[240:243]
    v_mfma_f32_16x16x32_bf16 v[244:247], v[84:87], v[224:227], v[244:247]
    ds_read_b64_tr_b16 v[134:135], v10 offset:46112
    v_mfma_f32_16x16x32_bf16 v[248:251], v[88:91], v[224:227], v[248:251]
    v_mfma_f32_16x16x32_bf16 v[252:255], v[92:95], v[224:227], v[252:255]
    s_waitcnt vmcnt(1) lgkmcnt(2)
    v_mfma_f32_16x16x32_bf16 v[236:239], v[96:99], v[228:231], v[236:239]
    v_mfma_f32_16x16x32_bf16 v[240:243], v[100:103], v[228:231], v[240:243]
    v_mfma_f32_16x16x32_bf16 v[244:247], v[104:107], v[228:231], v[244:247]
    v_mfma_f32_16x16x32_bf16 v[248:251], v[108:111], v[228:231], v[248:251]
    v_mfma_f32_16x16x32_bf16 v[252:255], v[112:115], v[228:231], v[252:255]
    s_waitcnt vmcnt(0) lgkmcnt(0)
    v_mfma_f32_16x16x32_bf16 v[236:239], v[116:119], v[232:235], v[236:239]
    v_mfma_f32_16x16x32_bf16 v[240:243], v[120:123], v[232:235], v[240:243]
    v_mfma_f32_16x16x32_bf16 v[244:247], v[124:127], v[232:235], v[244:247]
    v_mfma_f32_16x16x32_bf16 v[248:251], v[128:131], v[232:235], v[248:251]
    v_mfma_f32_16x16x32_bf16 v[252:255], v[132:135], v[232:235], v[252:255]
    s_nop 3
    v_cvt_pk_bf16_f32 v64, v236, v237
    v_cvt_pk_bf16_f32 v65, v238, v239
    ds_write_b64 v11, v[64:65] offset:0
    v_cvt_pk_bf16_f32 v66, v240, v241
    v_cvt_pk_bf16_f32 v67, v242, v243
    ds_write_b64 v11, v[66:67] offset:8
    v_cvt_pk_bf16_f32 v68, v244, v245
    v_cvt_pk_bf16_f32 v69, v246, v247
    ds_write_b64 v11, v[68:69] offset:16
    v_cvt_pk_bf16_f32 v70, v248, v249
    v_cvt_pk_bf16_f32 v71, v250, v251
    ds_write_b64 v11, v[70:71] offset:24
    v_cvt_pk_bf16_f32 v72, v252, v253
    v_cvt_pk_bf16_f32 v73, v254, v255
    ds_write_b64 v11, v[72:73] offset:32
    ds_read_b128 v[80:83], v12 offset:0
    ds_read_b128 v[84:87], v12 offset:1024
    ds_read_b128 v[88:91], v12 offset:2048
    s_waitcnt lgkmcnt(2)
    buffer_store_dwordx4 v[80:83], v13, s[36:39], s60 offen nt
    s_waitcnt lgkmcnt(1)
    buffer_store_dwordx4 v[84:87], v14, s[36:39], s60 offen nt
    s_mov_b32 exec_hi, 0
    s_waitcnt lgkmcnt(0)
    buffer_store_dwordx4 v[88:91], v15, s[36:39], s60 offen nt
L_end:
    s_endpgm
L_chk:
    s_call_b64 s[22:23], L_su1
    s_call_b64 s[22:23], L_su2
    s_branch L_chkx
L_atom:
    s_mov_b64 exec, 1
    s_waitcnt vmcnt(0)
    buffer_store_dword v23, off, s[44:47], s66 sc1
    s_mov_b64 exec, -1
    s_branch L_atomx
L_kvget:
    s_lshl_b32 s9, s50, 1
    s_add_u32 s9, s9, s48
    s_lshl_b32 s9, s9, 6
    s_add_u32 s9, s9, 17823744
    s_xor_b32 s8, s48, 1
    s_mul_i32 s8, s8, 22528
    s_sub_u32 s7, s61, 675840
    s_add_u32 s7, s7, s8
    s_mov_b32 s4, 0
    s_branch L_pl_kv
L_pw_kv:
    s_cmp_eq_u32 s6, 1073741824
    s_cbranch_scc1 L_pl_kv
    s_mov_b64 exec, 1
    s_waitcnt vmcnt(0)
    buffer_store_dword v23, off, s[40:43], s6 offset:64 sc1
    s_mov_b64 exec, -1
    s_mov_b32 s6, 1073741824
L_pl_kv:
    s_load_dwordx4 s[12:15], s[40:41], s9 glc
L_pc_kv:
    s_add_u32 s4, s4, 1
    s_cmp_gt_u32 s4, 65536
    s_waitcnt lgkmcnt(0)
    s_cbranch_scc1 L_px_kv
    s_and_b64 s[12:13], s[12:13], s[14:15]
    s_and_b32 s12, s12, s13
    s_cbranch_scc0 L_pw_kv
L_px_kv:
    s_mov_b32 s4, 5
L_kvld:
    s_mov_b32 m0, s8
    s_addk_i32 s8, 4096
    buffer_load_dwordx4 v16, s[40:43], s7 offen sc1 lds
    buffer_load_dwordx4 v16, s[40:43], s7 offen offset:1024 sc1 lds
    s_sub_u32 s4, s4, 1
    s_cbranch_scc1 L_kvx
    buffer_load_dwordx4 v16, s[40:43], s7 offen offset:2048 sc1 lds
    buffer_load_dwordx4 v16, s[40:43], s7 offen offset:3072 sc1 lds
    s_addk_i32 s7, 4096
    s_branch L_kvld
L_kvx:
    s_setpc_b64 s[22:23]
L_st0:
    v_readfirstlane_b32 s5, v28
    ds_write_b32 v24, v23 offset:32
    s_and_b32 s5, s5, s55
    s_movk_i32 s55, 2
    s_cbranch_scc1 L_bk0
    s_movk_i32 s63, 0
    s_call_b64 s[20:21], L_event
    s_branch L_bk0
L_st1:
    v_readfirstlane_b32 s5, v28
    ds_write_b32 v24, v23 offset:32
    s_and_b32 s5, s5, s55
    s_movk_i32 s55, 2
    s_cbranch_scc1 L_bk1
    s_movk_i32 s63, 1
    s_call_b64 s[20:21], L_event
    s_branch L_bk1
L_st2:
    v_readfirstlane_b32 s5, v28
    ds_write_b32 v24, v23 offset:32
    s_and_b32 s5, s5, s55
    s_movk_i32 s55, 2
    s_cbranch_scc1 L_bk2
    s_movk_i32 s63, 2
    s_call_b64 s[20:21], L_event
    s_branch L_bk2
L_st3:
    v_readfirstlane_b32 s5, v28
    ds_write_b32 v24, v23 offset:32
    s_and_b32 s5, s5, s55
    s_movk_i32 s55, 2
    s_cbranch_scc1 L_bk3
    s_movk_i32 s63, 3
    s_call_b64 s[20:21], L_event
    s_branch L_bk3
L_st4:
    v_readfirstlane_b32 s5, v28
    ds_write_b32 v24, v23 offset:32
    s_and_b32 s5, s5, s55
    s_movk_i32 s55, 2
    s_cbranch_scc1 L_bk4
    s_movk_i32 s63, 4
    s_call_b64 s[20:21], L_event
    s_branch L_bk4
L_st5:
    v_readfirstlane_b32 s5, v28
    ds_write_b32 v24, v23 offset:32
    s_and_b32 s5, s5, s55
    s_movk_i32 s55, 2
    s_cbranch_scc1 L_bk5
    s_movk_i32 s63, 5
    s_call_b64 s[20:21], L_event
    s_branch L_bk5
L_st6:
    v_readfirstlane_b32 s5, v28
    ds_write_b32 v24, v23 offset:32
    s_and_b32 s5, s5, s55
    s_movk_i32 s55, 2
    s_cbranch_scc1 L_bk6
    s_movk_i32 s63, 6
    s_call_b64 s[20:21], L_event
    s_branch L_bk6
L_st7:
    v_readfirstlane_b32 s5, v28
    ds_write_b32 v24, v23 offset:32
    s_and_b32 s5, s5, s55
    s_movk_i32 s55, 2
    s_cbranch_scc1 L_bk7
    s_movk_i32 s63, 7
    s_call_b64 s[20:21], L_event
    s_branch L_bk7
L_event:
    s_sub_u32 s11, 7, s63
    s_mulk_i32 s11, 5632
    s_cmp_lg_u32 s49, 0
    s_cbranch_scc1 L_ev_1
    s_addk_i32 s11, 5632
    v_add_u32 v20, s11, v20
    s_setprio 0
    s_cmp_lg_u32 s63, 0
    s_cbranch_scc1 L_bk8
    v_mov_b32 v128, 0
    v_mov_b32 v129, 0
    v_mov_b32 v130, 0
    v_mov_b32 v131, 0
    v_mov_b32 v132, 0
    v_mov_b32 v133, 0
    v_mov_b32 v134, 0
    v_mov_b32 v135, 0
    v_mov_b32 v136, 0
    v_mov_b32 v137, 0
    v_mov_b32 v138, 0
    v_mov_b32 v139, 0
    v_mov_b32 v140, 0
    v_mov_b32 v141, 0
    v_mov_b32 v142, 0
    v_mov_b32 v143, 0
    v_mov_b32 v144, 0
    v_mov_b32 v145, 0
    v_mov_b32 v146, 0
    v_mov_b32 v147, 0
    v_mov_b32 v148, 0
    v_mov_b32 v149, 0
    v_mov_b32 v150, 0
    v_mov_b32 v151, 0
    v_mov_b32 v152, 0
    v_mov_b32 v153, 0
    v_mov_b32 v154, 0
    v_mov_b32 v155, 0
    v_mov_b32 v156, 0
    v_mov_b32 v157, 0
    v_mov_b32 v158, 0
    v_mov_b32 v159, 0
    s_branch L_bk8
L_ev_1:
    s_cmp_lg_u32 s48, 1
    s_cbranch_scc1 L_ev_sp
    s_mov_b32 s6, 1073741824
    s_call_b64 s[22:23], L_kvget
    v_mov_b32 v7, 2
    s_mov_b64 exec, 1
    s_waitcnt vmcnt(0)
    ds_or_b32 v22, v7 offset:8
    s_mov_b64 exec, -1
    s_setprio 0
L_ev_sp:
    v_add_u32 v2, s11, v19
    v_add_u32 v3, s11, v21
    s_cmp_eq_u32 s63, s53
    s_cselect_b32 s6, 1, 2
    s_mov_b32 s4, 0
L_ev_s1:
    ds_read_b32 v28, v22 offset:8
    ds_read_b128 v[96:99], v2
    ds_read_b64 v[104:105], v3
    s_add_u32 s4, s4, 1
    s_waitcnt lgkmcnt(0)
    v_readfirstlane_b32 s5, v28
    s_cmp_gt_u32 s4, 1048576
    s_cbranch_scc1 L_ev_x
    s_and_b32 s5, s5, s6
    s_cbranch_scc1 L_ev_x
    s_sleep 1
    s_branch L_ev_s1
L_ev_x:
    s_setpc_b64 s[20:21]
L_hi3:
    s_mov_b64 exec, -1
    v_and_b32 v6, 7, v0
    v_lshl_add_u32 v6, v6, 2, v22
    s_mov_b32 s4, 0
L_pl:
    ds_read_b32 v7, v6 offset:32
    s_add_u32 s4, s4, 1
    s_waitcnt lgkmcnt(0)
    v_cmp_eq_u32 vcc, 0, v7
    s_cmp_gt_u32 s4, 1048576
    s_cbranch_scc1 L_plx
    s_cbranch_vccz L_plx
    s_sleep 1
    s_branch L_pl
L_plx:
    s_mul_i32 s4, s48, 5
    s_sub_u32 s4, s4, 20
    s_lshr_b32 s4, 12884064, s4
    s_and_b32 s8, s4, 31
    s_bfe_u32 s11, s4, 0x50005
    s_add_u32 s9, s8, 1
    s_mov_b32 s10, 1
    s_call_b64 s[22:23], L_wodma
    s_mov_b64 exec, 0xff
    s_waitcnt vmcnt(5)
    buffer_store_dword v23, v25, s[40:43], s57 offen sc1
    s_mov_b64 exec, -1
    s_mov_b32 s9, s11
    s_call_b64 s[22:23], L_wodma
    s_load_dwordx16 s[12:27], s[40:41], s58 glc
    s_mov_b32 s4, 0
    s_mov_b64 exec, 1
    s_waitcnt vmcnt(0)
    ds_add_u32 v22, v23
    s_mov_b64 exec, -1
    s_setprio 0
    s_branch L_pc_o
L_wodma:
    s_mul_i32 s4, s8, 5120
    s_add_u32 m0, s4, 61184
    s_lshr_b32 s5, s59, 11
    s_add_u32 s5, s5, s8
    s_cmp_ge_u32 s5, 20
    s_cselect_b32 s3, 20, 0
    s_sub_u32 s5, s5, s3
    s_mul_i32 s5, s5, 40960
    buffer_load_dwordx4 v192, s[32:35], s5 offen offset:0 lds
    buffer_load_dwordx4 v193, s[32:35], s5 offen offset:1024 lds
    buffer_load_dwordx4 v194, s[32:35], s5 offen offset:2048 lds
    buffer_load_dwordx4 v195, s[32:35], s5 offen offset:3072 lds
    s_add_u32 m0, s4, 65280
    s_add_u32 s8, s8, s10
    buffer_load_dwordx4 v196, s[32:35], s5 offen lds
    s_cmp_lt_u32 s8, s9
    s_cbranch_scc1 L_wodma
    s_setpc_b64 s[22:23]
L_wpre:
    s_mov_b32 s4, 0
    s_cmp_lt_u32 s48, 4
    s_cselect_b32 s6, 8, 0
L_ws:
    ds_read_b64 v[2:3], v22
    s_add_u32 s4, s4, 1
    s_waitcnt lgkmcnt(0)
    v_readfirstlane_b32 s5, v2
    v_readfirstlane_b32 s7, v3
    s_cmp_gt_u32 s4, 1048576
    s_cbranch_scc1 L_wx
    s_cmp_ge_u32 s7, s6
    s_cselect_b32 s5, s5, 0
    s_cmp_ge_u32 s5, 4
    s_cbranch_scc1 L_wx
    s_sleep 4
    s_branch L_ws
L_wx:
    ds_read_b64_tr_b16 v[16:17], v9 offset:0
    ds_read_b64_tr_b16 v[18:19], v10 offset:0
    ds_read_b64_tr_b16 v[20:21], v9 offset:8
    ds_read_b64_tr_b16 v[22:23], v10 offset:8
    ds_read_b64_tr_b16 v[24:25], v9 offset:16
    ds_read_b64_tr_b16 v[26:27], v10 offset:16
    ds_read_b64_tr_b16 v[28:29], v9 offset:24
    ds_read_b64_tr_b16 v[30:31], v10 offset:24
    ds_read_b64_tr_b16 v[32:33], v9 offset:32
    ds_read_b64_tr_b16 v[34:35], v10 offset:32
    ds_read_b64_tr_b16 v[36:37], v9 offset:5120
    ds_read_b64_tr_b16 v[38:39], v10 offset:5120
    ds_read_b64_tr_b16 v[40:41], v9 offset:5128
    ds_read_b64_tr_b16 v[42:43], v10 offset:5128
    ds_read_b64_tr_b16 v[44:45], v9 offset:5136
    ds_read_b64_tr_b16 v[46:47], v10 offset:5136
    ds_read_b64_tr_b16 v[48:49], v9 offset:5144
    ds_read_b64_tr_b16 v[50:51], v10 offset:5144
    ds_read_b64_tr_b16 v[52:53], v9 offset:5152
    ds_read_b64_tr_b16 v[54:55], v10 offset:5152
    ds_read_b64_tr_b16 v[56:57], v9 offset:10240
    ds_read_b64_tr_b16 v[58:59], v10 offset:10240
    ds_read_b64_tr_b16 v[60:61], v9 offset:10248
    ds_read_b64_tr_b16 v[62:63], v10 offset:10248
    ds_read_b64_tr_b16 v[64:65], v9 offset:10256
    ds_read_b64_tr_b16 v[66:67], v10 offset:10256
    ds_read_b64_tr_b16 v[68:69], v9 offset:10264
    ds_read_b64_tr_b16 v[70:71], v10 offset:10264
    ds_read_b64_tr_b16 v[72:73], v9 offset:10272
    ds_read_b64_tr_b16 v[74:75], v10 offset:10272
    ds_read_b64_tr_b16 v[76:77], v9 offset:15360
    ds_read_b64_tr_b16 v[78:79], v10 offset:15360
    ds_read_b64_tr_b16 v[80:81], v9 offset:15368
    ds_read_b64_tr_b16 v[82:83], v10 offset:15368
    ds_read_b64_tr_b16 v[84:85], v9 offset:15376
    ds_read_b64_tr_b16 v[86:87], v10 offset:15376
    ds_read_b64_tr_b16 v[88:89], v9 offset:15384
    ds_read_b64_tr_b16 v[90:91], v10 offset:15384
    ds_read_b64_tr_b16 v[92:93], v9 offset:15392
    ds_read_b64_tr_b16 v[94:95], v10 offset:15392
    ds_read_b64_tr_b16 v[96:97], v9 offset:20480
    ds_read_b64_tr_b16 v[98:99], v10 offset:20480
    ds_read_b64_tr_b16 v[100:101], v9 offset:20488
    ds_read_b64_tr_b16 v[102:103], v10 offset:20488
    ds_read_b64_tr_b16 v[104:105], v9 offset:20496
    ds_read_b64_tr_b16 v[106:107], v10 offset:20496
    ds_read_b64_tr_b16 v[108:109], v9 offset:20504
    ds_read_b64_tr_b16 v[110:111], v10 offset:20504
    ds_read_b64_tr_b16 v[112:113], v9 offset:20512
    ds_read_b64_tr_b16 v[114:115], v10 offset:20512
    ds_read_b64_tr_b16 v[116:117], v9 offset:25600
    ds_read_b64_tr_b16 v[118:119], v10 offset:25600
    ds_read_b64_tr_b16 v[120:121], v9 offset:25608
    ds_read_b64_tr_b16 v[122:123], v10 offset:25608
    ds_read_b64_tr_b16 v[124:125], v9 offset:25616
    ds_read_b64_tr_b16 v[126:127], v10 offset:25616
    ds_read_b64_tr_b16 v[128:129], v9 offset:25624
    ds_read_b64_tr_b16 v[130:131], v10 offset:25624
    ds_read_b64_tr_b16 v[132:133], v9 offset:25632
    ds_read_b64_tr_b16 v[134:135], v10 offset:25632
    ds_read_b64_tr_b16 v[136:137], v9 offset:30720
    ds_read_b64_tr_b16 v[138:139], v10 offset:30720
    ds_read_b64_tr_b16 v[140:141], v9 offset:30728
    ds_read_b64_tr_b16 v[142:143], v10 offset:30728
    ds_read_b64_tr_b16 v[144:145], v9 offset:30736
    ds_read_b64_tr_b16 v[146:147], v10 offset:30736
    ds_read_b64_tr_b16 v[148:149], v9 offset:30744
    ds_read_b64_tr_b16 v[150:151], v10 offset:30744
    ds_read_b64_tr_b16 v[152:153], v9 offset:30752
    ds_read_b64_tr_b16 v[154:155], v10 offset:30752
    s_setpc_b64 s[22:23]
L_codeend:
L_slow:
    s_lshl_b32 s6, s50, 7
    s_add_u32 s6, s6, 17825792
    s_mov_b32 s4, 0
    s_branch L_pl_s0
L_pw_s0:
L_pl_s0:
    s_load_dwordx4 s[12:15], s[40:41], s6 glc
L_pc_s0:
    s_add_u32 s4, s4, 1
    s_cmp_gt_u32 s4, 65536
    s_waitcnt lgkmcnt(0)
    s_cbranch_scc1 L_px_s0
    s_and_b64 s[12:13], s[12:13], s[14:15]
    s_and_b32 s12, s12, s13
    s_cbranch_scc0 L_pw_s0
L_px_s0:
    s_add_u32 s6, s6, 64
    s_mov_b32 s4, 0
    s_branch L_pl_s1
L_pw_s1:
L_pl_s1:
    s_load_dwordx4 s[12:15], s[40:41], s6 glc
L_pc_s1:
    s_add_u32 s4, s4, 1
    s_cmp_gt_u32 s4, 65536
    s_waitcnt lgkmcnt(0)
    s_cbranch_scc1 L_px_s1
    s_and_b64 s[12:13], s[12:13], s[14:15]
    s_and_b32 s12, s12, s13
    s_cbranch_scc0 L_pw_s1
L_px_s1:
    v_and_b32 v1, 31, v0
    v_lshrrev_b32 v5, 5, v0
    v_lshlrev_b32 v5, 2, v5
    v_sub_u32 v31, v1, v5
    v_mov_b32 v7, 0xff800000
    s_add_u32 s8, s53, 1
    s_cmp_eq_u32 s49, 0
    s_cselect_b32 s8, s8, 9
    s_movk_i32 s9, 0x100
    v_mov_b32 v30, v7
    s_add_u32 s4, s53, 8
    s_mulk_i32 s4, 5632
    s_add_u32 s4, s4, s61
    v_mov_b32 v4, v31
    s_mov_b32 s5, 0
L_sl00:
    buffer_load_dwordx4 v[96:99], v16, s[40:43], s4 offen offset:0 sc1
    buffer_load_dwordx2 v[104:105], v18, s[40:43], s4 offen sc1
    v_subrev_u32 v1, 0, v4
    v_cmp_gt_u32 vcc, s9, v1
    s_nop 1
    v_cndmask_b32 v176, v7, 0, vcc
    v_subrev_u32 v1, 1, v4
    v_cmp_gt_u32 vcc, s9, v1
    s_nop 1
    v_cndmask_b32 v177, v7, 0, vcc
    v_subrev_u32 v1, 2, v4
    v_cmp_gt_u32 vcc, s9, v1
    s_nop 1
    v_cndmask_b32 v178, v7, 0, vcc
    v_subrev_u32 v1, 3, v4
    v_cmp_gt_u32 vcc, s9, v1
    s_nop 1
    v_cndmask_b32 v179, v7, 0, vcc
    v_subrev_u32 v1, 8, v4
    v_cmp_gt_u32 vcc, s9, v1
    s_nop 1
    v_cndmask_b32 v180, v7, 0, vcc
    v_subrev_u32 v1, 9, v4
    v_cmp_gt_u32 vcc, s9, v1
    s_nop 1
    v_cndmask_b32 v181, v7, 0, vcc
    v_subrev_u32 v1, 10, v4
    v_cmp_gt_u32 vcc, s9, v1
    s_nop 1
    v_cndmask_b32 v182, v7, 0, vcc
    v_subrev_u32 v1, 11, v4
    v_cmp_gt_u32 vcc, s9, v1
    s_nop 1
    v_cndmask_b32 v183, v7, 0, vcc
    v_subrev_u32 v1, 16, v4
    v_cmp_gt_u32 vcc, s9, v1
    s_nop 1
    v_cndmask_b32 v184, v7, 0, vcc
    v_subrev_u32 v1, 17, v4
    v_cmp_gt_u32 vcc, s9, v1
    s_nop 1
    v_cndmask_b32 v185, v7, 0, vcc
    v_subrev_u32 v1, 18, v4
    v_cmp_gt_u32 vcc, s9, v1
    s_nop 1
    v_cndmask_b32 v186, v7, 0, vcc
    v_subrev_u32 v1, 19, v4
    v_cmp_gt_u32 vcc, s9, v1
    s_nop 1
    v_cndmask_b32 v187, v7, 0, vcc
    v_subrev_u32 v1, 24, v4
    v_cmp_gt_u32 vcc, s9, v1
    s_nop 1
    v_cndmask_b32 v188, v7, 0, vcc
    v_subrev_u32 v1, 25, v4
    v_cmp_gt_u32 vcc, s9, v1
    s_nop 1
    v_cndmask_b32 v189, v7, 0, vcc
    v_subrev_u32 v1, 26, v4
    v_cmp_gt_u32 vcc, s9, v1
    s_nop 1
    v_cndmask_b32 v190, v7, 0, vcc
    v_subrev_u32 v1, 27, v4
    v_cmp_gt_u32 vcc, s9, v1
    s_nop 1
    v_cndmask_b32 v191, v7, 0, vcc
    s_waitcnt vmcnt(0)
    s_nop 1
    v_mfma_f32_32x32x16_bf16 v[160:175], v[96:99], v[80:83], v[176:191]
    v_mfma_f32_32x32x16_bf16 v[160:175], v[104:107], v[88:91], v[160:175]
    s_nop 15
    v_max3_f32 v30, v160, v161, v30
    v_max3_f32 v30, v162, v163, v30
    v_max3_f32 v30, v164, v165, v30
    v_max3_f32 v30, v166, v167, v30
    v_max3_f32 v30, v168, v169, v30
    v_max3_f32 v30, v170, v171, v30
    v_max3_f32 v30, v172, v173, v30
    v_max3_f32 v30, v174, v175, v30
    s_cmp_eq_u32 s5, s53
    s_cselect_b32 s6, 675840, 0
    s_add_u32 s6, s6, 5632
    s_sub_u32 s4, s4, s6
    v_add_u32 v4, 32, v4
    s_add_u32 s5, s5, 1
    s_cmp_lt_u32 s5, s8
    s_cbranch_scc1 L_sl00
    v_mov_b32 v1, v30
    s_nop 1
    v_permlane32_swap_b32 v1, v30
    s_nop 1
    v_max_f32 v30, v1, v30
    v_mov_b32 v128, 0
    v_mov_b32 v129, 0
    v_mov_b32 v130, 0
    v_mov_b32 v131, 0
    v_mov_b32 v132, 0
    v_mov_b32 v133, 0
    v_mov_b32 v134, 0
    v_mov_b32 v135, 0
    v_mov_b32 v136, 0
    v_mov_b32 v137, 0
    v_mov_b32 v138, 0
    v_mov_b32 v139, 0
    v_mov_b32 v140, 0
    v_mov_b32 v141, 0
    v_mov_b32 v142, 0
    v_mov_b32 v143, 0
    s_add_u32 s4, s53, 8
    s_mulk_i32 s4, 5632
    s_add_u32 s4, s4, s61
    v_mov_b32 v4, v31
    s_mov_b32 s5, 0
L_sl01:
    buffer_load_dwordx4 v[96:99], v16, s[40:43], s4 offen offset:0 sc1
    buffer_load_dwordx2 v[104:105], v18, s[40:43], s4 offen sc1
    buffer_load_dwordx4 v[112:115], v17, s[40:43], s4 offen offset:0 sc1
    buffer_load_dwordx4 v[116:119], v17, s[40:43], s4 offen offset:768 sc1
    v_subrev_u32 v1, 0, v4
    v_cmp_gt_u32 vcc, s9, v1
    s_nop 1
    v_cndmask_b32 v176, v7, 0, vcc
    v_subrev_u32 v1, 1, v4
    v_cmp_gt_u32 vcc, s9, v1
    s_nop 1
    v_cndmask_b32 v177, v7, 0, vcc
    v_subrev_u32 v1, 2, v4
    v_cmp_gt_u32 vcc, s9, v1
    s_nop 1
    v_cndmask_b32 v178, v7, 0, vcc
    v_subrev_u32 v1, 3, v4
    v_cmp_gt_u32 vcc, s9, v1
    s_nop 1
    v_cndmask_b32 v179, v7, 0, vcc
    v_subrev_u32 v1, 8, v4
    v_cmp_gt_u32 vcc, s9, v1
    s_nop 1
    v_cndmask_b32 v180, v7, 0, vcc
    v_subrev_u32 v1, 9, v4
    v_cmp_gt_u32 vcc, s9, v1
    s_nop 1
    v_cndmask_b32 v181, v7, 0, vcc
    v_subrev_u32 v1, 10, v4
    v_cmp_gt_u32 vcc, s9, v1
    s_nop 1
    v_cndmask_b32 v182, v7, 0, vcc
    v_subrev_u32 v1, 11, v4
    v_cmp_gt_u32 vcc, s9, v1
    s_nop 1
    v_cndmask_b32 v183, v7, 0, vcc
    v_subrev_u32 v1, 16, v4
    v_cmp_gt_u32 vcc, s9, v1
    s_nop 1
    v_cndmask_b32 v184, v7, 0, vcc
    v_subrev_u32 v1, 17, v4
    v_cmp_gt_u32 vcc, s9, v1
    s_nop 1
    v_cndmask_b32 v185, v7, 0, vcc
    v_subrev_u32 v1, 18, v4
    v_cmp_gt_u32 vcc, s9, v1
    s_nop 1
    v_cndmask_b32 v186, v7, 0, vcc
    v_subrev_u32 v1, 19, v4
    v_cmp_gt_u32 vcc, s9, v1
    s_nop 1
    v_cndmask_b32 v187, v7, 0, vcc
    v_subrev_u32 v1, 24, v4
    v_cmp_gt_u32 vcc, s9, v1
    s_nop 1
    v_cndmask_b32 v188, v7, 0, vcc
    v_subrev_u32 v1, 25, v4
    v_cmp_gt_u32 vcc, s9, v1
    s_nop 1
    v_cndmask_b32 v189, v7, 0, vcc
    v_subrev_u32 v1, 26, v4
    v_cmp_gt_u32 vcc, s9, v1
    s_nop 1
    v_cndmask_b32 v190, v7, 0, vcc
    v_subrev_u32 v1, 27, v4
    v_cmp_gt_u32 vcc, s9, v1
    s_nop 1
    v_cndmask_b32 v191, v7, 0, vcc
    s_waitcnt vmcnt(0)
    s_nop 1
    v_mfma_f32_32x32x16_bf16 v[160:175], v[96:99], v[80:83], v[176:191]
    v_mfma_f32_32x32x16_bf16 v[160:175], v[104:107], v[88:91], v[160:175]
    s_nop 15
    v_sub_f32 v160, v160, v30
    v_sub_f32 v161, v161, v30
    v_sub_f32 v162, v162, v30
    v_sub_f32 v163, v163, v30
    v_sub_f32 v164, v164, v30
    v_sub_f32 v165, v165, v30
    v_sub_f32 v166, v166, v30
    v_sub_f32 v167, v167, v30
    v_sub_f32 v168, v168, v30
    v_sub_f32 v169, v169, v30
    v_sub_f32 v170, v170, v30
    v_sub_f32 v171, v171, v30
    v_sub_f32 v172, v172, v30
    v_sub_f32 v173, v173, v30
    v_sub_f32 v174, v174, v30
    v_sub_f32 v175, v175, v30
    v_exp_f32 v160, v160
    v_exp_f32 v161, v161
    v_exp_f32 v162, v162
    v_exp_f32 v163, v163
    v_cvt_pk_bf16_f32 v64, v160, v161
    v_exp_f32 v164, v164
    v_exp_f32 v165, v165
    v_cvt_pk_bf16_f32 v65, v162, v163
    v_exp_f32 v166, v166
    v_exp_f32 v167, v167
    v_cvt_pk_bf16_f32 v66, v164, v165
    v_exp_f32 v168, v168
    v_exp_f32 v169, v169
    v_cvt_pk_bf16_f32 v67, v166, v167
    v_exp_f32 v170, v170
    v_exp_f32 v171, v171
    v_cvt_pk_bf16_f32 v68, v168, v169
    v_exp_f32 v172, v172
    v_exp_f32 v173, v173
    v_cvt_pk_bf16_f32 v69, v170, v171
    v_exp_f32 v174, v174
    v_exp_f32 v175, v175
    v_cvt_pk_bf16_f32 v70, v172, v173
    v_cvt_pk_bf16_f32 v71, v174, v175
    s_nop 1
    v_mfma_f32_32x32x16_bf16 v[128:143], v[112:115], v[64:67], v[128:143]
    v_mfma_f32_32x32x16_bf16 v[128:143], v[116:119], v[68:71], v[128:143]
    s_nop 15
    s_cmp_eq_u32 s5, s53
    s_cselect_b32 s6, 675840, 0
    s_add_u32 s6, s6, 5632
    s_sub_u32 s4, s4, s6
    v_add_u32 v4, 32, v4
    s_add_u32 s5, s5, 1
    s_cmp_lt_u32 s5, s8
    s_cbranch_scc1 L_sl01
    v_mov_b32 v30, v7
    s_add_u32 s4, s53, 8
    s_mulk_i32 s4, 5632
    s_add_u32 s4, s4, s61
    v_mov_b32 v4, v31
    s_mov_b32 s5, 0
L_sl10:
    buffer_load_dwordx4 v[96:99], v16, s[40:43], s4 offen offset:1024 sc1
    buffer_load_dwordx2 v[104:105], v18, s[40:43], s4 offen sc1
    v_subrev_u32 v1, 0, v4
    v_cmp_gt_u32 vcc, s9, v1
    s_nop 1
    v_cndmask_b32 v176, v7, 0, vcc
    v_subrev_u32 v1, 1, v4
    v_cmp_gt_u32 vcc, s9, v1
    s_nop 1
    v_cndmask_b32 v177, v7, 0, vcc
    v_subrev_u32 v1, 2, v4
    v_cmp_gt_u32 vcc, s9, v1
    s_nop 1
    v_cndmask_b32 v178, v7, 0, vcc
    v_subrev_u32 v1, 3, v4
    v_cmp_gt_u32 vcc, s9, v1
    s_nop 1
    v_cndmask_b32 v179, v7, 0, vcc
    v_subrev_u32 v1, 8, v4
    v_cmp_gt_u32 vcc, s9, v1
    s_nop 1
    v_cndmask_b32 v180, v7, 0, vcc
    v_subrev_u32 v1, 9, v4
    v_cmp_gt_u32 vcc, s9, v1
    s_nop 1
    v_cndmask_b32 v181, v7, 0, vcc
    v_subrev_u32 v1, 10, v4
    v_cmp_gt_u32 vcc, s9, v1
    s_nop 1
    v_cndmask_b32 v182, v7, 0, vcc
    v_subrev_u32 v1, 11, v4
    v_cmp_gt_u32 vcc, s9, v1
    s_nop 1
    v_cndmask_b32 v183, v7, 0, vcc
    v_subrev_u32 v1, 16, v4
    v_cmp_gt_u32 vcc, s9, v1
    s_nop 1
    v_cndmask_b32 v184, v7, 0, vcc
    v_subrev_u32 v1, 17, v4
    v_cmp_gt_u32 vcc, s9, v1
    s_nop 1
    v_cndmask_b32 v185, v7, 0, vcc
    v_subrev_u32 v1, 18, v4
    v_cmp_gt_u32 vcc, s9, v1
    s_nop 1
    v_cndmask_b32 v186, v7, 0, vcc
    v_subrev_u32 v1, 19, v4
    v_cmp_gt_u32 vcc, s9, v1
    s_nop 1
    v_cndmask_b32 v187, v7, 0, vcc
    v_subrev_u32 v1, 24, v4
    v_cmp_gt_u32 vcc, s9, v1
    s_nop 1
    v_cndmask_b32 v188, v7, 0, vcc
    v_subrev_u32 v1, 25, v4
    v_cmp_gt_u32 vcc, s9, v1
    s_nop 1
    v_cndmask_b32 v189, v7, 0, vcc
    v_subrev_u32 v1, 26, v4
    v_cmp_gt_u32 vcc, s9, v1
    s_nop 1
    v_cndmask_b32 v190, v7, 0, vcc
    v_subrev_u32 v1, 27, v4
    v_cmp_gt_u32 vcc, s9, v1
    s_nop 1
    v_cndmask_b32 v191, v7, 0, vcc
    s_waitcnt vmcnt(0)
    s_nop 1
    v_mfma_f32_32x32x16_bf16 v[160:175], v[96:99], v[84:87], v[176:191]
    v_mfma_f32_32x32x16_bf16 v[160:175], v[104:107], v[92:95], v[160:175]
    s_nop 15
    v_max3_f32 v30, v160, v161, v30
    v_max3_f32 v30, v162, v163, v30
    v_max3_f32 v30, v164, v165, v30
    v_max3_f32 v30, v166, v167, v30
    v_max3_f32 v30, v168, v169, v30
    v_max3_f32 v30, v170, v171, v30
    v_max3_f32 v30, v172, v173, v30
    v_max3_f32 v30, v174, v175, v30
    s_cmp_eq_u32 s5, s53
    s_cselect_b32 s6, 675840, 0
    s_add_u32 s6, s6, 5632
    s_sub_u32 s4, s4, s6
    v_add_u32 v4, 32, v4
    s_add_u32 s5, s5, 1
    s_cmp_lt_u32 s5, s8
    s_cbranch_scc1 L_sl10
    v_mov_b32 v1, v30
    s_nop 1
    v_permlane32_swap_b32 v1, v30
    s_nop 1
    v_max_f32 v30, v1, v30
    v_mov_b32 v144, 0
    v_mov_b32 v145, 0
    v_mov_b32 v146, 0
    v_mov_b32 v147, 0
    v_mov_b32 v148, 0
    v_mov_b32 v149, 0
    v_mov_b32 v150, 0
    v_mov_b32 v151, 0
    v_mov_b32 v152, 0
    v_mov_b32 v153, 0
    v_mov_b32 v154, 0
    v_mov_b32 v155, 0
    v_mov_b32 v156, 0
    v_mov_b32 v157, 0
    v_mov_b32 v158, 0
    v_mov_b32 v159, 0
    s_add_u32 s4, s53, 8
    s_mulk_i32 s4, 5632
    s_add_u32 s4, s4, s61
    v_mov_b32 v4, v31
    s_mov_b32 s5, 0
L_sl11:
    buffer_load_dwordx4 v[96:99], v16, s[40:43], s4 offen offset:1024 sc1
    buffer_load_dwordx2 v[104:105], v18, s[40:43], s4 offen sc1
    buffer_load_dwordx4 v[112:115], v17, s[40:43], s4 offen offset:1536 sc1
    buffer_load_dwordx4 v[116:119], v17, s[40:43], s4 offen offset:2304 sc1
    v_subrev_u32 v1, 0, v4
    v_cmp_gt_u32 vcc, s9, v1
    s_nop 1
    v_cndmask_b32 v176, v7, 0, vcc
    v_subrev_u32 v1, 1, v4
    v_cmp_gt_u32 vcc, s9, v1
    s_nop 1
    v_cndmask_b32 v177, v7, 0, vcc
    v_subrev_u32 v1, 2, v4
    v_cmp_gt_u32 vcc, s9, v1
    s_nop 1
    v_cndmask_b32 v178, v7, 0, vcc
    v_subrev_u32 v1, 3, v4
    v_cmp_gt_u32 vcc, s9, v1
    s_nop 1
    v_cndmask_b32 v179, v7, 0, vcc
    v_subrev_u32 v1, 8, v4
    v_cmp_gt_u32 vcc, s9, v1
    s_nop 1
    v_cndmask_b32 v180, v7, 0, vcc
    v_subrev_u32 v1, 9, v4
    v_cmp_gt_u32 vcc, s9, v1
    s_nop 1
    v_cndmask_b32 v181, v7, 0, vcc
    v_subrev_u32 v1, 10, v4
    v_cmp_gt_u32 vcc, s9, v1
    s_nop 1
    v_cndmask_b32 v182, v7, 0, vcc
    v_subrev_u32 v1, 11, v4
    v_cmp_gt_u32 vcc, s9, v1
    s_nop 1
    v_cndmask_b32 v183, v7, 0, vcc
    v_subrev_u32 v1, 16, v4
    v_cmp_gt_u32 vcc, s9, v1
    s_nop 1
    v_cndmask_b32 v184, v7, 0, vcc
    v_subrev_u32 v1, 17, v4
    v_cmp_gt_u32 vcc, s9, v1
    s_nop 1
    v_cndmask_b32 v185, v7, 0, vcc
    v_subrev_u32 v1, 18, v4
    v_cmp_gt_u32 vcc, s9, v1
    s_nop 1
    v_cndmask_b32 v186, v7, 0, vcc
    v_subrev_u32 v1, 19, v4
    v_cmp_gt_u32 vcc, s9, v1
    s_nop 1
    v_cndmask_b32 v187, v7, 0, vcc
    v_subrev_u32 v1, 24, v4
    v_cmp_gt_u32 vcc, s9, v1
    s_nop 1
    v_cndmask_b32 v188, v7, 0, vcc
    v_subrev_u32 v1, 25, v4
    v_cmp_gt_u32 vcc, s9, v1
    s_nop 1
    v_cndmask_b32 v189, v7, 0, vcc
    v_subrev_u32 v1, 26, v4
    v_cmp_gt_u32 vcc, s9, v1
    s_nop 1
    v_cndmask_b32 v190, v7, 0, vcc
    v_subrev_u32 v1, 27, v4
    v_cmp_gt_u32 vcc, s9, v1
    s_nop 1
    v_cndmask_b32 v191, v7, 0, vcc
    s_waitcnt vmcnt(0)
    s_nop 1
    v_mfma_f32_32x32x16_bf16 v[160:175], v[96:99], v[84:87], v[176:191]
    v_mfma_f32_32x32x16_bf16 v[160:175], v[104:107], v[92:95], v[160:175]
    s_nop 15
    v_sub_f32 v160, v160, v30
    v_sub_f32 v161, v161, v30
    v_sub_f32 v162, v162, v30
    v_sub_f32 v163, v163, v30
    v_sub_f32 v164, v164, v30
    v_sub_f32 v165, v165, v30
    v_sub_f32 v166, v166, v30
    v_sub_f32 v167, v167, v30
    v_sub_f32 v168, v168, v30
    v_sub_f32 v169, v169, v30
    v_sub_f32 v170, v170, v30
    v_sub_f32 v171, v171, v30
    v_sub_f32 v172, v172, v30
    v_sub_f32 v173, v173, v30
    v_sub_f32 v174, v174, v30
    v_sub_f32 v175, v175, v30
    v_exp_f32 v160, v160
    v_exp_f32 v161, v161
    v_exp_f32 v162, v162
    v_exp_f32 v163, v163
    v_cvt_pk_bf16_f32 v64, v160, v161
    v_exp_f32 v164, v164
    v_exp_f32 v165, v165
    v_cvt_pk_bf16_f32 v65, v162, v163
    v_exp_f32 v166, v166
    v_exp_f32 v167, v167
    v_cvt_pk_bf16_f32 v66, v164, v165
    v_exp_f32 v168, v168
    v_exp_f32 v169, v169
    v_cvt_pk_bf16_f32 v67, v166, v167
    v_exp_f32 v170, v170
    v_exp_f32 v171, v171
    v_cvt_pk_bf16_f32 v68, v168, v169
    v_exp_f32 v172, v172
    v_exp_f32 v173, v173
    v_cvt_pk_bf16_f32 v69, v170, v171
    v_exp_f32 v174, v174
    v_exp_f32 v175, v175
    v_cvt_pk_bf16_f32 v70, v172, v173
    v_cvt_pk_bf16_f32 v71, v174, v175
    s_nop 1
    v_mfma_f32_32x32x16_bf16 v[144:159], v[112:115], v[64:67], v[144:159]
    v_mfma_f32_32x32x16_bf16 v[144:159], v[116:119], v[68:71], v[144:159]
    s_nop 15
    s_cmp_eq_u32 s5, s53
    s_cselect_b32 s6, 675840, 0
    s_add_u32 s6, s6, 5632
    s_sub_u32 s4, s4, s6
    v_add_u32 v4, 32, v4
    s_add_u32 s5, s5, 1
    s_cmp_lt_u32 s5, s8
    s_cbranch_scc1 L_sl11
    v_rcp_f32 v2, v140
    s_mov_b32 s4, -1
    s_branch L_fin
.section .rodata,"a"
.p2align 6
.amdhsa_kernel concat_heads__sliding_block__sliding_block__prompt_kernel
  .amdhsa_next_free_vgpr 256
  .amdhsa_next_free_sgpr 102
  .amdhsa_accum_offset 256
  .amdhsa_group_segment_fixed_size 0
  .amdhsa_kernarg_size 72
  .amdhsa_user_sgpr_count 2
  .amdhsa_user_sgpr_kernarg_segment_ptr 1
  .amdhsa_system_sgpr_workgroup_id_x 1
.end_amdhsa_kernel
```
